```python
import torch

def _softmax(x, axis=-1):
    return torch.softmax(x, dim=axis)
def _gelu(x):
    return torch.nn.functional.gelu(x, approximate="tanh")
def _silu(x):
    return torch.nn.functional.silu(x)
def _sigmoid(x):
    return torch.sigmoid(x)
def _layernorm(x, axis=-1, eps=1e-5):
    m = x.mean(dim=axis, keepdim=True)
    v = x.var(dim=axis, keepdim=True, unbiased=False)
    return (x - m) / torch.sqrt(v + eps)
def _scatter_add(tgt, idx, src, axis=0):
    return tgt.clone().index_add_(axis, idx, src)
def _segment_sum(src, seg, n):
    out = torch.zeros((n,) + src.shape[1:], dtype=src.dtype)
    return out.index_add_(0, seg, src)
def _pad(x, pw):
    flat = tuple(v for pair in reversed(pw) for v in pair)
    return torch.nn.functional.pad(x, flat)

kernel_name = 'concat_heads__grouped_kv_mqa__ssm_conv_s4__prompt'

def setup_inputs():

    _w = (lambda a: (lambda t: t.to(torch.bfloat16) if t.is_floating_point() else t)(torch.as_tensor(a)))
    def _A_setup():
        B, S, D, H = 1, 2048, 512, 32
        Dh = D // H
        return {
            "x": _w((lambda *s: torch.randn(*s, dtype=torch.bfloat16) * 0.05)(B, S, D)),
            "wq": _w((lambda *s: torch.randn(*s, dtype=torch.bfloat16) * 0.8)(D, H * Dh)),
            "wk": _w((lambda *s: torch.randn(*s, dtype=torch.bfloat16) * 0.8)(D, Dh)),
            "wv": _w((lambda *s: torch.randn(*s, dtype=torch.bfloat16) * 0.05)(D, Dh)),
            "wo": _w((lambda *s: torch.randn(*s, dtype=torch.bfloat16) * 0.05)(H * Dh, D)),
        }
    _A_in = _A_setup()

    def _B_setup():
        B, L, D, N = 1, 2048, 512, 128
        A_re = -(lambda _x: torch.exp(torch.as_tensor(_x)))((lambda *s: torch.randn(*s, dtype=torch.bfloat16) * 3.2)(D, N))
        A_im = torch.pi * (lambda *s: torch.randn(*s, dtype=torch.bfloat16) * 0.05)(D, N)
        B_re = (lambda *s: torch.randn(*s, dtype=torch.bfloat16) * 0.1)(D, N)
        B_im = (lambda *s: torch.randn(*s, dtype=torch.bfloat16) * 0.1)(D, N)
        C_re = (lambda *s: torch.randn(*s, dtype=torch.bfloat16) * 0.1)(D, N)
        C_im = (lambda *s: torch.randn(*s, dtype=torch.bfloat16) * 0.1)(D, N)
        log_dt = (lambda *s: torch.randn(*s, dtype=torch.bfloat16) * 0.05)(D) * 0.5 - 4.0
        Dskip = (lambda *s: torch.randn(*s, dtype=torch.bfloat16) * 0.05)(D)
        return {
            "u": _w((lambda *s: torch.randn(*s, dtype=torch.bfloat16) * 0.05)(B, L, D)),
            "A_re": _w(A_re),
            "A_im": _w(A_im),
            "B_re": _w(B_re),
            "B_im": _w(B_im),
            "C_re": _w(C_re),
            "C_im": _w(C_im),
            "log_dt": _w(log_dt),
            "Dskip": _w(Dskip),
        }
    _B_in = _B_setup()

    return {
        "A_x": _A_in["x"],
        "A_wq": _A_in["wq"],
        "A_wk": _A_in["wk"],
        "A_wv": _A_in["wv"],
        "A_wo": _A_in["wo"],
        "B_u": _B_in["u"],
        "B_A_re": _B_in["A_re"],
        "B_A_im": _B_in["A_im"],
        "B_B_re": _B_in["B_re"],
        "B_B_im": _B_in["B_im"],
        "B_C_re": _B_in["C_re"],
        "B_C_im": _B_in["C_im"],
        "B_log_dt": _B_in["log_dt"],
        "B_Dskip": _B_in["Dskip"],
    }

def reference(A_x, A_wq, A_wk, A_wv, A_wo, B_u, B_A_re, B_A_im, B_B_re, B_B_im, B_C_re, B_C_im, B_log_dt, B_Dskip):
    def _A_ref(x, wq, wk, wv, wo):
        B, S, D = x.shape
        H = 32
        Dh = D // H
        q = (lambda x, *d: x.permute(*d))((x @ wq).reshape(B, S, H, Dh), 0, 2, 1, 3)
        k = x @ wk
        v = x @ wv
        scores = torch.einsum("bhqd,bkd->bhqk", q, k) * (Dh ** -0.5)
        p = _softmax(scores, axis=-1)
        o = torch.einsum("bhqk,bkd->bhqd", p, v)
        return (lambda x, *d: x.permute(*d))(o, 0, 2, 1, 3).reshape(B, S, H * Dh) @ wo

    def _B_ref(u, A_re, A_im, B_re, B_im, C_re, C_im, log_dt, Dskip):
        Bsz, L, D = u.shape
        dt = torch.exp(log_dt)[:, None]
        A = A_re + 1j * A_im
        Bc = B_re + 1j * B_im
        Cc = C_re + 1j * C_im
        logdA = dt * A
        dB = dt * Bc
        l = (lambda x, dt: x.to(dt))(torch.arange(L), A_re.dtype)
        P = torch.exp(logdA[:, :, None] * l[None, None, :])
        K = torch.einsum("dn,dnl,dn->dl", Cc, P, dB).real
        L2 = 2 * L
        Kp = _pad(K, ((0, 0), (0, L)))
        up = (lambda x, *d: x.permute(*d))(u, 0, 2, 1)
        up = _pad(up, ((0, 0), (0, 0), (0, L)))
        Kf = (lambda x, axes=(-2,-1): torch.fft.rfft2(x.float(), dim=axes))(Kp[:, None, :], axes=(-2, -1))
        Uf = (lambda x, axes=(-2,-1): torch.fft.rfft2(x.float(), dim=axes))(up[:, :, None, :], axes=(-2, -1))
        Yf = Uf * Kf[None, :, :, :]
        y = (lambda x, s, axes=(-2,-1): torch.fft.irfft2(x, s=s, dim=axes).to(torch.bfloat16))(Yf, (1, L2), axes=(-2, -1))[:, :, 0, :L]
        y = (lambda x, *d: x.permute(*d))(y, 0, 2, 1) + u * Dskip[None, None, :]
        return y

    a = _A_ref(A_x, A_wq, A_wk, A_wv, A_wo)
    b = _B_ref(B_u, B_A_re, B_A_im, B_B_re, B_B_im, B_C_re, B_C_im, B_log_dt, B_Dskip)
    return torch.concatenate([a, b], axis=-1)
```

```asm
; @launch grid=(256,1,1) block=(512,1,1) lds=163840
.amdgcn_target "amdgcn-amd-amdhsa--gfx950"
.text
.globl concat_heads__grouped_kv_mqa__ssm_conv_s4__prompt_kernel
.p2align 8
.type concat_heads__grouped_kv_mqa__ssm_conv_s4__prompt_kernel,@function
concat_heads__grouped_kv_mqa__ssm_conv_s4__prompt_kernel:
    s_cmp_ge_u32 s2, 256
    s_cbranch_scc1 L_end
    s_load_dwordx16 s[16:31], s[0:1], 0
    s_load_dwordx16 s[32:47], s[0:1], 64
    s_load_dwordx2 s[48:49], s[0:1], 128
    s_getpc_b64 s[78:79]
L_pc:
    s_lshr_b32 s72, s2, 3
    s_and_b32 s72, s72, 31
    s_mul_i32 s72, s72, 8
    v_subrev_u32 v6, 504, v0
    v_cmp_gt_u32 vcc, 8, v6
    v_add_u32 v6, s72, v6
    v_lshlrev_b32 v6, 7, v6
    s_mov_b32 s72, L_codeend-L_pc-4
    v_min_u32 v6, s72, v6
    s_and_saveexec_b64 s[74:75], vcc
    s_cbranch_execz L_nopf
    global_load_dword v10, v6, s[78:79]
L_nopf:
    s_mov_b64 exec, -1
    v_lshrrev_b32 v6, 6, v0
    v_and_b32 v1, 63, v0
    v_readfirstlane_b32 s3, v6
    v_and_b32 v2, 31, v0
    v_bfe_u32 v3, v0, 5, 1
    v_lshlrev_b32 v4, 4, v1
    v_lshrrev_b32 v6, 3, v1
    v_bfe_u32 v7, v1, 4, 1
    v_lshlrev_b32 v7, 2, v7
    v_and_b32 v8, 7, v1
    v_xor_b32 v8, v8, v7
    v_lshlrev_b32 v8, 4, v8
    v_lshl_add_u32 v5, v6, 10, v8
    s_and_b32 s72, s2, 7
    s_lshr_b32 s73, s2, 3
    s_and_b32 s5, s73, 7
    s_lshr_b32 s74, s73, 3
    s_lshl_b32 s4, s72, 2
    s_add_u32 s4, s4, s74
    s_lshl_b32 s6, s72, 6
    s_lshl_b32 s73, s73, 1
    s_add_u32 s6, s6, s73
    s_lshr_b32 s83, s3, 2
    s_lshr_b32 s77, s5, 1
    s_lshl_b32 s77, s77, 4
    s_cmp_lt_u32 s3, 4
    s_cbranch_scc1 L_ld_proj
    s_setprio 3
    s_sub_u32 s73, s3, 4
    s_lshl_b32 s74, s73, 7
    s_lshl_b32 s72, s6, 8
    s_add_u32 s72, s72, s74
    v_lshl_add_u32 v6, v1, 1, s72
    s_lshl_b32 s75, s73, 11
    s_add_u32 s75, s75, 65536
    s_lshl_b32 s76, s73, 14
    s_lshl_b32 s72, s5, 7
    s_add_u32 s76, s76, s72
    s_waitcnt lgkmcnt(0)
    global_load_ushort v12, v6, s[28:29]
    global_load_ushort v13, v6, s[30:31]
    global_load_ushort v14, v6, s[32:33]
    global_load_ushort v15, v6, s[34:35]
    global_load_ushort v16, v6, s[36:37]
    global_load_ushort v17, v6, s[38:39]
    s_mov_b32 s52, s18
    s_mov_b32 s53, s19
    s_mov_b32 s54, 524288
    s_mov_b32 s55, 0x00020000
    s_mov_b32 s0, s75
    s_mov_b32 s1, s76
    s_setprio 0
    s_lshl_b32 s72, s6, 1
    s_load_dword s7, s[48:49], 0
    s_load_dword s80, s[40:41], s72
    s_load_dword s81, s[42:43], s72
    s_mov_b32 s8, s48
    s_mov_b32 s9, s49
    s_mov_b32 s10, 25165824
    s_mov_b32 s11, 0x00020000
    s_mov_b32 s60, s24
    s_mov_b32 s61, s25
    s_mov_b32 s62, 524288
    s_mov_b32 s63, 0x00020000
    s_mov_b32 s64, s26
    s_mov_b32 s65, s27
    s_mov_b32 s66, 2097152
    s_mov_b32 s67, 0x00020000
    s_mov_b32 s68, s44
    s_mov_b32 s69, s45
    s_mov_b32 s70, 4194304
    s_mov_b32 s71, 0x00020000
    v_mov_b32 v19, 0
    v_add_u32 v20, 131072, v4
    v_lshlrev_b32 v32, 4, v0
    s_and_b32 s72, s2, 7
    v_lshrrev_b32 v6, 2, v2
    v_add_u32 v6, s72, v6
    v_and_b32 v6, 7, v6
    v_lshl_add_u32 v6, v6, 3, s3
    v_lshl_add_u32 v6, v3, 2, v6
    v_and_b32 v7, 3, v1
    v_lshl_add_u32 v6, v6, 2, v7
    v_lshlrev_b32 v6, 5, v6
    v_add_u32 v21, 4096, v6
    s_lshl_b32 s50, s72, 3
    s_add_u32 s50, s50, s3
    s_lshl_b32 s50, s50, 11
    s_mul_i32 s51, s3, 2080
    s_mul_i32 s72, s83, 8320
    v_add_u32 v23, s72, v4
    v_lshlrev_b32 v6, 4, v2
    v_lshl_add_u32 v6, v3, 8, v6
    v_add_u32 v7, 1024, v6
    v_add_u32 v8, 1536, v6
    v_and_b32 v9, 27, v2
    v_cmp_eq_u32 s[78:79], 16, v9
    v_mov_b32 v9, 2064
    v_mov_b32 v22, 2048
    v_cndmask_b32 v9, v9, v22, s[78:79]
    v_cmp_gt_u32 s[78:79], 16, v2
    v_mov_b32 v22, 0xdddd
    s_nop 0
    v_cndmask_b32 v7, v9, v7, s[78:79]
    v_cndmask_b32 v8, v9, v8, s[78:79]
    v_add_u32 v24, s72, v7
    v_add_u32 v25, s72, v8
    s_and_b32 s72, s3, 3
    s_mul_i32 s73, s83, 16640
    s_lshl_b32 s74, s72, 9
    s_add_u32 s73, s73, s74
    s_add_u32 s73, s73, 33288
    v_and_b32 v6, 3, v1
    v_mul_u32_u24 v26, 4160, v6
    v_and_b32 v6, 28, v1
    v_lshl_add_u32 v26, v6, 1, v26
    v_lshl_add_u32 v26, v3, 4, v26
    v_add_u32 v26, s73, v26
    s_mul_i32 s73, s83, 7600
    s_mul_i32 s74, s72, 640
    s_add_u32 s73, s73, s74
    s_add_u32 s73, s73, 69056
    v_mul_u32_u24 v6, 80, v2
    v_sub_u32 v27, s73, v6
    v_lshl_add_u32 v27, v3, 4, v27
    s_mul_i32 s72, s3, 9216
    s_add_u32 s72, s72, 81792
    v_mul_u32_u24 v6, 144, v2
    v_lshl_add_u32 v6, v3, 4, v6
    v_add_u32 v29, s72, v6
    v_lshrrev_b32 v7, 3, v0
    v_and_b32 v8, 7, v0
    v_mul_u32_u24 v6, 144, v7
    v_lshl_add_u32 v6, v8, 4, v6
    v_add_u32 v30, 81792, v6
    v_mul_u32_u24 v7, 80, v7
    v_lshl_add_u32 v7, v8, 3, v7
    v_sub_u32 v31, 71672, v7
    v_lshrrev_b32 v6, 4, v1
    v_and_b32 v7, 15, v1
    v_lshlrev_b32 v28, 9, v6
    v_lshlrev_b32 v33, 13, v6
    v_lshl_add_u32 v33, v7, 4, v33
    v_lshl_add_u32 v34, v7, 2, v6
    s_and_b32 s72, s3, 3
    s_lshl_b32 s72, s72, 10
    s_mul_i32 s73, s83, 4160
    s_add_u32 s73, s73, s72
    s_add_u32 s73, s73, 147516
    v_add_u32 v35, s73, v4
    s_mul_i32 s73, s83, 16640
    s_add_u32 s73, s73, 33288
    v_lshrrev_b32 v8, 3, v2
    v_mul_u32_u24 v8, 4160, v8
    v_and_b32 v9, 7, v1
    v_lshl_add_u32 v8, v9, 3, v8
    v_add_u32 v40, s73, v8
    v_lshlrev_b32 v43, 2, v9
    s_add_u32 s73, s73, s72
    s_add_u32 s73, s73, 52
    v_add_u32 v36, s73, v4
    v_mov_b32 v38, 0x3f803f80
    v_cmp_gt_u32 s[78:79], 4, v9
    v_mul_u32_u24 v8, 16640, v3
    s_nop 0
    v_cndmask_b32 v38, 0, v38, s[78:79]
    v_add3_u32 v37, v43, v8, s51
    v_min_u32 v8, 309, v0
    s_movk_i32 s74, 154
    v_cmp_lt_u32 s[78:79], s74, v8
    v_lshlrev_b32 v8, 4, v8
    v_add_u32 v9, 5120, v8
    v_cndmask_b32 v8, v8, v9, s[78:79]
    v_add_u32 v39, 71696, v8
    s_barrier
    s_mov_b32 m0, s0
    s_setprio 3
    buffer_load_dwordx4 v5, s[52:55], s1 offen lds
    s_add_u32 m0, s0, 1024
    s_add_u32 s1, s1, 8192
    buffer_load_dwordx4 v5, s[52:55], s1 offen lds
    s_setprio 0
    s_mul_i32 s72, s3, 3072
    s_add_u32 s72, s72, 65536
    v_add_u32 v41, s72, v4
    s_xor_b32 s73, s3, 4
    s_mul_i32 s73, s73, 3072
    s_add_u32 s73, s73, 65536
    v_add_u32 v42, s73, v4
    s_waitcnt lgkmcnt(0)
    s_add_u32 s7, s7, 0x9e3779b0
    s_and_b32 s7, s7, -16
    v_mov_b32 v11, s7
    s_getreg_b32 s36, hwreg(HW_REG_XCC_ID, 0, 4)
    s_or_b32 s36, s36, s7
    v_mov_b32 v18, s36
    s_and_b32 s34, s3, 1
    s_bfe_u32 s35, s3, 0x10001
    s_lshl_b32 s16, s81, 16
    s_and_b32 s17, s81, 0xffff0000
    s_lshl_b32 s72, s6, 12
    s_add_u32 s22, s72, 4194304
    s_add_u32 s18, s72, 6291456
    s_lshl_b32 s21, s3, 11
    s_and_b32 s72, s2, 7
    s_lshl_b32 s72, s72, 6
    s_add_u32 s21, s21, s72
    s_lshr_b32 s72, s2, 6
    s_lshl_b32 s72, s72, 2
    s_add_u32 s21, s21, s72
    s_add_u32 s21, s21, 65536
    s_lshl_b32 s23, s6, 5
    s_lshl_b32 s72, s3, 2
    s_add_u32 s23, s23, s72
    s_add_u32 s23, s23, 81920
    s_lshl_b32 s19, s3, 13
    s_add_u32 s19, s19, 98048
    s_lshl_b32 s20, s3, 16
    s_lshl_b32 s73, s5, 7
    s_add_u32 s20, s20, s73
    s_mov_b32 s24, 0x05040100
    s_mov_b32 s25, 0x07060302
    s_lshl_b32 s74, s4, 3
    s_add_u32 s75, s74, s5
    s_add_u32 s74, s74, s3
    s_lshl_b32 s26, s75, 7
    s_add_u32 s26, s26, s72
    s_add_u32 s26, s26, 32768
    s_lshl_b32 s27, s74, 7
    s_add_u32 s27, s27, 32768
    s_lshl_b32 s28, s75, 3
    s_add_u32 s28, s28, s3
    s_lshl_b32 s28, s28, 10
    s_add_u32 s28, s28, 2097152
    s_lshl_b32 s29, s74, 13
    s_add_u32 s29, s29, 2097152
    s_lshl_b32 s30, s75, 6
    s_add_u32 s30, s30, s72
    s_add_u32 s30, s30, 65520
    s_lshl_b32 s74, s5, 3
    s_add_u32 s74, s74, s3
    s_lshl_b32 s31, s74, 8
    s_lshr_b32 s76, s4, 2
    s_lshl_b32 s76, s76, 2
    s_add_u32 s31, s31, s76
    s_add_u32 s31, s31, 81920
    s_lshl_b32 s32, s74, 15
    s_lshl_b32 s76, s4, 8
    s_add_u32 s32, s32, s76
    s_add_u32 s32, s32, 6291456
    s_lshl_b32 s33, s4, 17
    s_add_u32 s33, s33, s73
    s_branch L_kgen
L_ld_proj:
    v_xor_b32 v6, v2, v3
    v_lshlrev_b32 v6, 4, v6
    v_lshl_add_u32 v104, v3, 10, v6
    v_xor_b32 v105, 32, v104
    v_xor_b32 v106, 64, v104
    v_xor_b32 v107, 96, v104
    v_xor_b32 v108, 128, v104
    v_xor_b32 v109, 160, v104
    v_xor_b32 v110, 192, v104
    v_xor_b32 v111, 224, v104
    s_lshl_b32 s72, s3, 4
    s_add_u32 s72, s72, s77
    s_and_b32 s72, s72, 63
    s_lshl_b32 s73, s72, 9
    s_lshl_b32 s74, s4, 6
    s_add_u32 s74, s74, s72
    s_lshl_b32 s74, s74, 10
    s_lshl_b32 s75, s3, 13
    s_add_u32 s75, s75, 65536
    s_lshl_b32 s76, s3, 16
    s_lshl_b32 s72, s5, 7
    s_add_u32 s76, s76, s72
    s_bitcmp1_b32 s5, 0
    s_waitcnt lgkmcnt(0)
    s_cselect_b32 s56, s22, s20
    s_cselect_b32 s57, s23, s21
    s_mov_b32 s58, 16384
    s_mov_b32 s59, 0x00020000
    s_mov_b32 s12, s16
    s_mov_b32 s13, s17
    s_mov_b32 s14, 2097152
    s_mov_b32 s15, 0x00020000
    s_mov_b32 s52, s18
    s_mov_b32 s53, s19
    s_mov_b32 s54, 524288
    s_mov_b32 s55, 0x00020000
    s_mov_b32 s0, s73
    s_mov_b32 s1, s74
    s_mov_b32 s46, s75
    s_mov_b32 s47, s76
    s_cmp_eq_u32 s3, 0
    s_cbranch_scc1 L_ld_crit
    s_setprio 1
    s_lshl_b32 s72, s6, 1
    s_load_dword s7, s[48:49], 0
    s_load_dword s80, s[40:41], s72
    s_load_dword s81, s[42:43], s72
    s_mov_b32 s8, s48
    s_mov_b32 s9, s49
    s_mov_b32 s10, 25165824
    s_mov_b32 s11, 0x00020000
    s_mov_b32 s60, s24
    s_mov_b32 s61, s25
    s_mov_b32 s62, 524288
    s_mov_b32 s63, 0x00020000
    s_mov_b32 s64, s26
    s_mov_b32 s65, s27
    s_mov_b32 s66, 2097152
    s_mov_b32 s67, 0x00020000
    s_mov_b32 s68, s44
    s_mov_b32 s69, s45
    s_mov_b32 s70, 4194304
    s_mov_b32 s71, 0x00020000
    v_mov_b32 v19, 0
    v_add_u32 v20, 131072, v4
    v_lshlrev_b32 v32, 4, v0
    s_and_b32 s72, s2, 7
    v_lshrrev_b32 v6, 2, v2
    v_add_u32 v6, s72, v6
    v_and_b32 v6, 7, v6
    v_lshl_add_u32 v6, v6, 3, s3
    v_lshl_add_u32 v6, v3, 2, v6
    v_and_b32 v7, 3, v1
    v_lshl_add_u32 v6, v6, 2, v7
    v_lshlrev_b32 v6, 5, v6
    v_add_u32 v21, 4096, v6
    s_lshl_b32 s50, s72, 3
    s_add_u32 s50, s50, s3
    s_lshl_b32 s50, s50, 11
    s_mul_i32 s51, s3, 2080
    s_mul_i32 s72, s83, 8320
    v_add_u32 v23, s72, v4
    v_lshlrev_b32 v6, 4, v2
    v_lshl_add_u32 v6, v3, 8, v6
    v_add_u32 v7, 1024, v6
    v_add_u32 v8, 1536, v6
    v_and_b32 v9, 27, v2
    v_cmp_eq_u32 s[78:79], 16, v9
    v_mov_b32 v9, 2064
    v_mov_b32 v22, 2048
    v_cndmask_b32 v9, v9, v22, s[78:79]
    v_cmp_gt_u32 s[78:79], 16, v2
    v_mov_b32 v22, 0xdddd
    s_nop 0
    v_cndmask_b32 v7, v9, v7, s[78:79]
    v_cndmask_b32 v8, v9, v8, s[78:79]
    v_add_u32 v24, s72, v7
    v_add_u32 v25, s72, v8
    s_and_b32 s72, s3, 3
    s_mul_i32 s73, s83, 16640
    s_lshl_b32 s74, s72, 9
    s_add_u32 s73, s73, s74
    s_add_u32 s73, s73, 33288
    v_and_b32 v6, 3, v1
    v_mul_u32_u24 v26, 4160, v6
    v_and_b32 v6, 28, v1
    v_lshl_add_u32 v26, v6, 1, v26
    v_lshl_add_u32 v26, v3, 4, v26
    v_add_u32 v26, s73, v26
    s_mul_i32 s73, s83, 7600
    s_mul_i32 s74, s72, 640
    s_add_u32 s73, s73, s74
    s_add_u32 s73, s73, 69056
    v_mul_u32_u24 v6, 80, v2
    v_sub_u32 v27, s73, v6
    v_lshl_add_u32 v27, v3, 4, v27
    s_mul_i32 s72, s3, 9216
    s_add_u32 s72, s72, 81792
    v_mul_u32_u24 v6, 144, v2
    v_lshl_add_u32 v6, v3, 4, v6
    v_add_u32 v29, s72, v6
    v_lshrrev_b32 v7, 3, v0
    v_and_b32 v8, 7, v0
    v_mul_u32_u24 v6, 144, v7
    v_lshl_add_u32 v6, v8, 4, v6
    v_add_u32 v30, 81792, v6
    v_mul_u32_u24 v7, 80, v7
    v_lshl_add_u32 v7, v8, 3, v7
    v_sub_u32 v31, 71672, v7
    v_lshrrev_b32 v6, 4, v1
    v_and_b32 v7, 15, v1
    v_lshlrev_b32 v28, 9, v6
    v_lshlrev_b32 v33, 13, v6
    v_lshl_add_u32 v33, v7, 4, v33
    v_lshl_add_u32 v34, v7, 2, v6
    s_and_b32 s72, s3, 3
    s_lshl_b32 s72, s72, 10
    s_mul_i32 s73, s83, 4160
    s_add_u32 s73, s73, s72
    s_add_u32 s73, s73, 147516
    v_add_u32 v35, s73, v4
    s_mul_i32 s73, s83, 16640
    s_add_u32 s73, s73, 33288
    v_lshrrev_b32 v8, 3, v2
    s_barrier
    s_mov_b32 s37, s72
    s_mov_b32 s38, s73
    v_mov_b32 v12, v6
    v_lshlrev_b32 v6, 7, v1
    s_lshr_b32 s72, s2, 3
    s_cmp_eq_u32 s3, 1
    s_cbranch_scc0 L_pfq
    s_branch L_pfd
L_pfq:
    s_sub_u32 s73, s3, 2
    s_lshl_b32 s73, s73, 5
    s_add_u32 s72, s72, s73
    s_lshl_b32 s72, s72, 13
    buffer_load_dword v10, v6, s[52:55], s72 offen
L_pfd:
    s_mov_b32 s72, s37
    s_mov_b32 s73, s38
    v_mov_b32 v6, v12
    s_add_u32 m0, s46, 0
    s_add_u32 s39, s47, 0
    buffer_load_dwordx4 v5, s[52:55], s39 offen lds
    s_add_u32 m0, s0, 0
    s_add_u32 s39, s1, 0
    buffer_load_dwordx4 v104, s[12:15], s39 offen lds
    s_add_u32 m0, s46, 1024
    s_add_u32 s39, s47, 8192
    buffer_load_dwordx4 v5, s[52:55], s39 offen lds
    s_add_u32 m0, s0, 1024
    s_add_u32 s39, s1, 2048
    buffer_load_dwordx4 v105, s[12:15], s39 offen lds
    s_add_u32 m0, s46, 2048
    s_add_u32 s39, s47, 16384
    buffer_load_dwordx4 v5, s[52:55], s39 offen lds
    v_mul_u32_u24 v8, 4160, v8
    v_and_b32 v9, 7, v1
    v_lshl_add_u32 v8, v9, 3, v8
    v_add_u32 v40, s73, v8
    v_lshlrev_b32 v43, 2, v9
    s_add_u32 s73, s73, s72
    s_add_u32 s73, s73, 52
    s_add_u32 m0, s0, 2048
    s_add_u32 s39, s1, 4096
    buffer_load_dwordx4 v106, s[12:15], s39 offen lds
    v_add_u32 v36, s73, v4
    v_mov_b32 v38, 0x3f803f80
    v_cmp_gt_u32 s[78:79], 4, v9
    v_mul_u32_u24 v8, 16640, v3
    s_nop 0
    v_cndmask_b32 v38, 0, v38, s[78:79]
    v_add3_u32 v37, v43, v8, s51
    v_min_u32 v8, 309, v0
    s_add_u32 m0, s46, 3072
    s_add_u32 s39, s47, 24576
    buffer_load_dwordx4 v5, s[52:55], s39 offen lds
    s_movk_i32 s74, 154
    v_cmp_lt_u32 s[78:79], s74, v8
    v_lshlrev_b32 v8, 4, v8
    v_add_u32 v9, 5120, v8
    v_cndmask_b32 v8, v8, v9, s[78:79]
    v_add_u32 v39, 71696, v8
    s_mul_i32 s72, s3, 3072
    s_add_u32 m0, s0, 3072
    s_add_u32 s39, s1, 6144
    buffer_load_dwordx4 v107, s[12:15], s39 offen lds
    s_add_u32 s72, s72, 65536
    v_add_u32 v41, s72, v4
    s_xor_b32 s73, s3, 4
    s_mul_i32 s73, s73, 3072
    s_add_u32 s73, s73, 65536
    v_add_u32 v42, s73, v4
    s_waitcnt lgkmcnt(0)
    s_add_u32 m0, s46, 4096
    s_add_u32 s39, s47, 32768
    buffer_load_dwordx4 v5, s[52:55], s39 offen lds
    s_add_u32 s7, s7, 0x9e3779b0
    s_and_b32 s7, s7, -16
    v_mov_b32 v11, s7
    s_getreg_b32 s36, hwreg(HW_REG_XCC_ID, 0, 4)
    s_or_b32 s36, s36, s7
    v_mov_b32 v18, s36
    s_and_b32 s34, s3, 1
    s_add_u32 m0, s0, 4096
    s_add_u32 s39, s1, 8192
    buffer_load_dwordx4 v108, s[12:15], s39 offen lds
    s_bfe_u32 s35, s3, 0x10001
    s_lshl_b32 s16, s81, 16
    s_and_b32 s17, s81, 0xffff0000
    s_lshl_b32 s72, s6, 12
    s_add_u32 s22, s72, 4194304
    s_add_u32 s18, s72, 6291456
    s_lshl_b32 s21, s3, 11
    s_add_u32 m0, s46, 5120
    s_add_u32 s39, s47, 40960
    buffer_load_dwordx4 v5, s[52:55], s39 offen lds
    s_and_b32 s72, s2, 7
    s_lshl_b32 s72, s72, 6
    s_add_u32 s21, s21, s72
    s_lshr_b32 s72, s2, 6
    s_lshl_b32 s72, s72, 2
    s_add_u32 s21, s21, s72
    s_add_u32 s21, s21, 65536
    s_add_u32 m0, s0, 5120
    s_add_u32 s39, s1, 10240
    buffer_load_dwordx4 v109, s[12:15], s39 offen lds
    s_lshl_b32 s23, s6, 5
    s_lshl_b32 s72, s3, 2
    s_add_u32 s23, s23, s72
    s_add_u32 s23, s23, 81920
    s_lshl_b32 s19, s3, 13
    s_add_u32 s19, s19, 98048
    s_lshl_b32 s20, s3, 16
    s_add_u32 m0, s46, 6144
    s_add_u32 s39, s47, 49152
    buffer_load_dwordx4 v5, s[52:55], s39 offen lds
    s_lshl_b32 s73, s5, 7
    s_add_u32 s20, s20, s73
    s_mov_b32 s24, 0x05040100
    s_mov_b32 s25, 0x07060302
    s_lshl_b32 s74, s4, 3
    s_add_u32 s75, s74, s5
    s_add_u32 s74, s74, s3
    s_add_u32 m0, s0, 6144
    s_add_u32 s39, s1, 12288
    buffer_load_dwordx4 v110, s[12:15], s39 offen lds
    s_lshl_b32 s26, s75, 7
    s_add_u32 s26, s26, s72
    s_add_u32 s26, s26, 32768
    s_lshl_b32 s27, s74, 7
    s_add_u32 s27, s27, 32768
    s_lshl_b32 s28, s75, 3
    s_add_u32 s28, s28, s3
    s_add_u32 m0, s46, 7168
    s_add_u32 s39, s47, 57344
    buffer_load_dwordx4 v5, s[52:55], s39 offen lds
    s_lshl_b32 s28, s28, 10
    s_add_u32 s28, s28, 2097152
    s_lshl_b32 s29, s74, 13
    s_add_u32 s29, s29, 2097152
    s_lshl_b32 s30, s75, 6
    s_add_u32 s30, s30, s72
    s_add_u32 s30, s30, 65520
    s_add_u32 m0, s0, 7168
    s_add_u32 s39, s1, 14336
    buffer_load_dwordx4 v111, s[12:15], s39 offen lds
    s_lshl_b32 s74, s5, 3
    s_add_u32 s74, s74, s3
    s_lshl_b32 s31, s74, 8
    s_lshr_b32 s76, s4, 2
    s_lshl_b32 s76, s76, 2
    s_add_u32 s31, s31, s76
    s_add_u32 s31, s31, 81920
    s_add_u32 m0, s0, 32768
    s_add_u32 s39, s1, 512
    buffer_load_dwordx4 v104, s[12:15], s39 offen lds
    s_lshl_b32 s32, s74, 15
    s_lshl_b32 s76, s4, 8
    s_add_u32 s32, s32, s76
    s_add_u32 s32, s32, 6291456
    s_lshl_b32 s33, s4, 17
    s_add_u32 s33, s33, s73
    v_bfe_u32 v6, v1, 2, 2
    s_add_u32 m0, s0, 33792
    s_add_u32 s39, s1, 2560
    buffer_load_dwordx4 v105, s[12:15], s39 offen lds
    v_lshl_add_u32 v7, v3, 3, v6
    v_lshlrev_b32 v85, 7, v7
    v_bfe_u32 v7, v1, 4, 1
    v_lshlrev_b32 v7, 1, v7
    v_bfe_u32 v8, v1, 1, 1
    v_add_u32 v7, v7, v8
    v_lshrrev_b32 v6, 1, v6
    s_add_u32 m0, s0, 34816
    s_add_u32 s39, s1, 4608
    buffer_load_dwordx4 v106, s[12:15], s39 offen lds
    v_xor_b32 v6, s34, v6
    v_lshl_add_u32 v7, v6, 2, v7
    v_lshl_add_u32 v85, v7, 4, v85
    v_and_b32 v8, 1, v1
    v_lshl_add_u32 v85, v8, 3, v85
    v_add_u32 v85, 65536, v85
    s_lshl_b32 s73, s35, 5
    s_add_u32 m0, s0, 35840
    s_add_u32 s39, s1, 6656
    buffer_load_dwordx4 v107, s[12:15], s39 offen lds
    v_add_u32 v6, s73, v2
    v_and_b32 v7, 15, v1
    v_xor_b32 v7, v7, v3
    v_lshlrev_b32 v6, 9, v6
    v_lshl_add_u32 v96, v7, 4, v6
    v_xor_b32 v97, 32, v96
    v_xor_b32 v98, 64, v96
    s_add_u32 m0, s0, 36864
    s_add_u32 s39, s1, 8704
    buffer_load_dwordx4 v108, s[12:15], s39 offen lds
    v_xor_b32 v99, 96, v96
    v_xor_b32 v100, 128, v96
    v_xor_b32 v101, 160, v96
    v_xor_b32 v102, 192, v96
    v_xor_b32 v103, 224, v96
    s_lshl_b32 s72, s3, 11
    s_add_u32 s72, s72, 131072
    s_add_u32 m0, s0, 37888
    s_add_u32 s39, s1, 10752
    buffer_load_dwordx4 v109, s[12:15], s39 offen lds
    v_add_u32 v94, s72, v4
    v_pk_mov_b32 v[44:45], 0, 0
    v_pk_mov_b32 v[46:47], 0, 0
    v_pk_mov_b32 v[48:49], 0, 0
    v_pk_mov_b32 v[50:51], 0, 0
    v_pk_mov_b32 v[52:53], 0, 0
    v_pk_mov_b32 v[54:55], 0, 0
    s_add_u32 m0, s0, 38912
    s_add_u32 s39, s1, 12800
    buffer_load_dwordx4 v110, s[12:15], s39 offen lds
    v_pk_mov_b32 v[56:57], 0, 0
    v_pk_mov_b32 v[58:59], 0, 0
    v_pk_mov_b32 v[60:61], 0, 0
    v_pk_mov_b32 v[62:63], 0, 0
    v_pk_mov_b32 v[64:65], 0, 0
    v_pk_mov_b32 v[66:67], 0, 0
    v_pk_mov_b32 v[68:69], 0, 0
    s_add_u32 m0, s0, 39936
    s_add_u32 s39, s1, 14848
    buffer_load_dwordx4 v111, s[12:15], s39 offen lds
    v_pk_mov_b32 v[70:71], 0, 0
    v_pk_mov_b32 v[72:73], 0, 0
    v_pk_mov_b32 v[74:75], 0, 0
    s_waitcnt vmcnt(8)
    s_branch L_b1a
L_ld_crit:
    s_setprio 2
    s_mov_b32 m0, 131072
    s_mov_b32 s39, 0
    buffer_load_dwordx4 v4, s[56:59], s39 offen lds
    buffer_load_dwordx4 v4, s[56:59], s39 offen offset:1024 lds
    buffer_load_dwordx4 v4, s[56:59], s39 offen offset:2048 lds
    buffer_load_dwordx4 v4, s[56:59], s39 offen offset:3072 lds
    s_add_u32 m0, s0, 0
    s_add_u32 s39, s1, 0
    buffer_load_dwordx4 v104, s[12:15], s39 offen lds
    s_add_u32 m0, s0, 1024
    s_add_u32 s39, s1, 2048
    buffer_load_dwordx4 v105, s[12:15], s39 offen lds
    s_add_u32 m0, s0, 2048
    s_add_u32 s39, s1, 4096
    buffer_load_dwordx4 v106, s[12:15], s39 offen lds
    s_add_u32 m0, s0, 3072
    s_add_u32 s39, s1, 6144
    buffer_load_dwordx4 v107, s[12:15], s39 offen lds
    s_mov_b32 m0, 135168
    s_mov_b32 s39, 4096
    buffer_load_dwordx4 v4, s[56:59], s39 offen lds
    buffer_load_dwordx4 v4, s[56:59], s39 offen offset:1024 lds
    buffer_load_dwordx4 v4, s[56:59], s39 offen offset:2048 lds
    buffer_load_dwordx4 v4, s[56:59], s39 offen offset:3072 lds
    s_add_u32 m0, s0, 4096
    s_add_u32 s39, s1, 8192
    buffer_load_dwordx4 v108, s[12:15], s39 offen lds
    s_add_u32 m0, s0, 5120
    s_add_u32 s39, s1, 10240
    buffer_load_dwordx4 v109, s[12:15], s39 offen lds
    s_add_u32 m0, s0, 6144
    s_add_u32 s39, s1, 12288
    buffer_load_dwordx4 v110, s[12:15], s39 offen lds
    s_add_u32 m0, s0, 7168
    s_add_u32 s39, s1, 14336
    buffer_load_dwordx4 v111, s[12:15], s39 offen lds
    s_mov_b32 m0, 139264
    s_mov_b32 s39, 8192
    buffer_load_dwordx4 v4, s[56:59], s39 offen lds
    buffer_load_dwordx4 v4, s[56:59], s39 offen offset:1024 lds
    buffer_load_dwordx4 v4, s[56:59], s39 offen offset:2048 lds
    buffer_load_dwordx4 v4, s[56:59], s39 offen offset:3072 lds
    s_add_u32 m0, s0, 32768
    s_add_u32 s39, s1, 512
    buffer_load_dwordx4 v104, s[12:15], s39 offen lds
    s_add_u32 m0, s0, 33792
    s_add_u32 s39, s1, 2560
    buffer_load_dwordx4 v105, s[12:15], s39 offen lds
    s_add_u32 m0, s0, 34816
    s_add_u32 s39, s1, 4608
    buffer_load_dwordx4 v106, s[12:15], s39 offen lds
    s_add_u32 m0, s0, 35840
    s_add_u32 s39, s1, 6656
    buffer_load_dwordx4 v107, s[12:15], s39 offen lds
    s_mov_b32 m0, 143360
    s_mov_b32 s39, 12288
    buffer_load_dwordx4 v4, s[56:59], s39 offen lds
    buffer_load_dwordx4 v4, s[56:59], s39 offen offset:1024 lds
    buffer_load_dwordx4 v4, s[56:59], s39 offen offset:2048 lds
    buffer_load_dwordx4 v4, s[56:59], s39 offen offset:3072 lds
    s_add_u32 m0, s0, 36864
    s_add_u32 s39, s1, 8704
    buffer_load_dwordx4 v108, s[12:15], s39 offen lds
    s_add_u32 m0, s0, 37888
    s_add_u32 s39, s1, 10752
    buffer_load_dwordx4 v109, s[12:15], s39 offen lds
    s_add_u32 m0, s0, 38912
    s_add_u32 s39, s1, 12800
    buffer_load_dwordx4 v110, s[12:15], s39 offen lds
    s_add_u32 m0, s0, 39936
    s_add_u32 s39, s1, 14848
    buffer_load_dwordx4 v111, s[12:15], s39 offen lds
    s_barrier
    s_setprio 2
    s_lshl_b32 s72, s6, 1
    s_load_dword s7, s[48:49], 0
    s_load_dword s80, s[40:41], s72
    s_load_dword s81, s[42:43], s72
    s_mov_b32 s8, s48
    s_mov_b32 s9, s49
    s_mov_b32 s10, 25165824
    s_mov_b32 s11, 0x00020000
    s_mov_b32 s60, s24
    s_mov_b32 s61, s25
    s_mov_b32 s62, 524288
    s_mov_b32 s63, 0x00020000
    s_mov_b32 s64, s26
    s_mov_b32 s65, s27
    s_mov_b32 s66, 2097152
    s_mov_b32 s67, 0x00020000
    s_mov_b32 s68, s44
    s_mov_b32 s69, s45
    s_mov_b32 s70, 4194304
    s_mov_b32 s71, 0x00020000
    v_mov_b32 v19, 0
    v_add_u32 v20, 131072, v4
    v_lshlrev_b32 v32, 4, v0
    s_and_b32 s72, s2, 7
    v_lshrrev_b32 v6, 2, v2
    v_add_u32 v6, s72, v6
    v_and_b32 v6, 7, v6
    v_lshl_add_u32 v6, v6, 3, s3
    v_lshl_add_u32 v6, v3, 2, v6
    v_and_b32 v7, 3, v1
    v_lshl_add_u32 v6, v6, 2, v7
    v_lshlrev_b32 v6, 5, v6
    v_add_u32 v21, 4096, v6
    s_lshl_b32 s50, s72, 3
    s_add_u32 s50, s50, s3
    s_lshl_b32 s50, s50, 11
    s_mul_i32 s51, s3, 2080
    s_mul_i32 s72, s83, 8320
    v_add_u32 v23, s72, v4
    v_lshlrev_b32 v6, 4, v2
    v_lshl_add_u32 v6, v3, 8, v6
    v_add_u32 v7, 1024, v6
    v_add_u32 v8, 1536, v6
    v_and_b32 v9, 27, v2
    v_cmp_eq_u32 s[78:79], 16, v9
    v_mov_b32 v9, 2064
    v_mov_b32 v22, 2048
    v_cndmask_b32 v9, v9, v22, s[78:79]
    v_cmp_gt_u32 s[78:79], 16, v2
    v_mov_b32 v22, 0xdddd
    s_nop 0
    v_cndmask_b32 v7, v9, v7, s[78:79]
    v_cndmask_b32 v8, v9, v8, s[78:79]
    v_add_u32 v24, s72, v7
    v_add_u32 v25, s72, v8
    s_and_b32 s72, s3, 3
    s_mul_i32 s73, s83, 16640
    s_lshl_b32 s74, s72, 9
    s_add_u32 s73, s73, s74
    s_add_u32 s73, s73, 33288
    v_and_b32 v6, 3, v1
    v_mul_u32_u24 v26, 4160, v6
    v_and_b32 v6, 28, v1
    v_lshl_add_u32 v26, v6, 1, v26
    v_lshl_add_u32 v26, v3, 4, v26
    v_add_u32 v26, s73, v26
    s_mul_i32 s73, s83, 7600
    s_mul_i32 s74, s72, 640
    s_add_u32 s73, s73, s74
    s_add_u32 s73, s73, 69056
    v_mul_u32_u24 v6, 80, v2
    v_sub_u32 v27, s73, v6
    v_lshl_add_u32 v27, v3, 4, v27
    s_mul_i32 s72, s3, 9216
    s_add_u32 s72, s72, 81792
    v_mul_u32_u24 v6, 144, v2
    v_lshl_add_u32 v6, v3, 4, v6
    v_add_u32 v29, s72, v6
    v_lshrrev_b32 v7, 3, v0
    v_and_b32 v8, 7, v0
    v_mul_u32_u24 v6, 144, v7
    v_lshl_add_u32 v6, v8, 4, v6
    v_add_u32 v30, 81792, v6
    v_mul_u32_u24 v7, 80, v7
    v_lshl_add_u32 v7, v8, 3, v7
    v_sub_u32 v31, 71672, v7
    v_lshrrev_b32 v6, 4, v1
    v_and_b32 v7, 15, v1
    v_lshlrev_b32 v28, 9, v6
    v_lshlrev_b32 v33, 13, v6
    v_lshl_add_u32 v33, v7, 4, v33
    v_lshl_add_u32 v34, v7, 2, v6
    s_and_b32 s72, s3, 3
    s_lshl_b32 s72, s72, 10
    s_mul_i32 s73, s83, 4160
    s_add_u32 s73, s73, s72
    s_add_u32 s73, s73, 147516
    v_add_u32 v35, s73, v4
    s_mul_i32 s73, s83, 16640
    s_add_u32 s73, s73, 33288
    v_lshrrev_b32 v8, 3, v2
    v_mul_u32_u24 v8, 4160, v8
    v_and_b32 v9, 7, v1
    v_lshl_add_u32 v8, v9, 3, v8
    v_add_u32 v40, s73, v8
    v_lshlrev_b32 v43, 2, v9
    s_add_u32 s73, s73, s72
    s_add_u32 s73, s73, 52
    v_add_u32 v36, s73, v4
    v_mov_b32 v38, 0x3f803f80
    v_cmp_gt_u32 s[78:79], 4, v9
    v_mul_u32_u24 v8, 16640, v3
    s_nop 0
    v_cndmask_b32 v38, 0, v38, s[78:79]
    v_add3_u32 v37, v43, v8, s51
    v_min_u32 v8, 309, v0
    s_movk_i32 s74, 154
    v_cmp_lt_u32 s[78:79], s74, v8
    v_lshlrev_b32 v8, 4, v8
    v_add_u32 v9, 5120, v8
    v_cndmask_b32 v8, v8, v9, s[78:79]
    v_add_u32 v39, 71696, v8
    s_mul_i32 s72, s3, 3072
    s_add_u32 s72, s72, 65536
    v_add_u32 v41, s72, v4
    s_xor_b32 s73, s3, 4
    s_mul_i32 s73, s73, 3072
    s_add_u32 s73, s73, 65536
    v_add_u32 v42, s73, v4
    s_waitcnt lgkmcnt(0)
    s_add_u32 s7, s7, 0x9e3779b0
    s_and_b32 s7, s7, -16
    v_mov_b32 v11, s7
    s_getreg_b32 s36, hwreg(HW_REG_XCC_ID, 0, 4)
    s_or_b32 s36, s36, s7
    v_mov_b32 v18, s36
    s_and_b32 s34, s3, 1
    s_bfe_u32 s35, s3, 0x10001
    s_lshl_b32 s16, s81, 16
    s_and_b32 s17, s81, 0xffff0000
    s_lshl_b32 s72, s6, 12
    s_add_u32 s22, s72, 4194304
    s_add_u32 s18, s72, 6291456
    s_lshl_b32 s21, s3, 11
    s_and_b32 s72, s2, 7
    s_lshl_b32 s72, s72, 6
    s_add_u32 s21, s21, s72
    s_lshr_b32 s72, s2, 6
    s_lshl_b32 s72, s72, 2
    s_add_u32 s21, s21, s72
    s_add_u32 s21, s21, 65536
    s_lshl_b32 s23, s6, 5
    s_lshl_b32 s72, s3, 2
    s_add_u32 s23, s23, s72
    s_add_u32 s23, s23, 81920
    s_lshl_b32 s19, s3, 13
    s_add_u32 s19, s19, 98048
    s_lshl_b32 s20, s3, 16
    s_lshl_b32 s73, s5, 7
    s_add_u32 s20, s20, s73
    s_mov_b32 s24, 0x05040100
    s_mov_b32 s25, 0x07060302
    s_lshl_b32 s74, s4, 3
    s_add_u32 s75, s74, s5
    s_add_u32 s74, s74, s3
    s_lshl_b32 s26, s75, 7
    s_add_u32 s26, s26, s72
    s_add_u32 s26, s26, 32768
    s_lshl_b32 s27, s74, 7
    s_add_u32 s27, s27, 32768
    s_lshl_b32 s28, s75, 3
    s_add_u32 s28, s28, s3
    s_lshl_b32 s28, s28, 10
    s_add_u32 s28, s28, 2097152
    s_lshl_b32 s29, s74, 13
    s_add_u32 s29, s29, 2097152
    s_lshl_b32 s30, s75, 6
    s_add_u32 s30, s30, s72
    s_add_u32 s30, s30, 65520
    s_lshl_b32 s74, s5, 3
    s_add_u32 s74, s74, s3
    s_lshl_b32 s31, s74, 8
    s_lshr_b32 s76, s4, 2
    s_lshl_b32 s76, s76, 2
    s_add_u32 s31, s31, s76
    s_add_u32 s31, s31, 81920
    s_lshl_b32 s32, s74, 15
    s_lshl_b32 s76, s4, 8
    s_add_u32 s32, s32, s76
    s_add_u32 s32, s32, 6291456
    s_lshl_b32 s33, s4, 17
    s_add_u32 s33, s33, s73
    v_bfe_u32 v6, v1, 2, 2
    v_lshl_add_u32 v7, v3, 3, v6
    v_lshlrev_b32 v85, 7, v7
    v_bfe_u32 v7, v1, 4, 1
    v_lshlrev_b32 v7, 1, v7
    v_bfe_u32 v8, v1, 1, 1
    v_add_u32 v7, v7, v8
    v_lshrrev_b32 v6, 1, v6
    v_xor_b32 v6, s34, v6
    v_lshl_add_u32 v7, v6, 2, v7
    v_lshl_add_u32 v85, v7, 4, v85
    v_and_b32 v8, 1, v1
    v_lshl_add_u32 v85, v8, 3, v85
    v_add_u32 v85, 65536, v85
    s_lshl_b32 s73, s35, 5
    v_add_u32 v6, s73, v2
    v_and_b32 v7, 15, v1
    v_xor_b32 v7, v7, v3
    v_lshlrev_b32 v6, 9, v6
    v_lshl_add_u32 v96, v7, 4, v6
    v_xor_b32 v97, 32, v96
    v_xor_b32 v98, 64, v96
    v_xor_b32 v99, 96, v96
    v_xor_b32 v100, 128, v96
    v_xor_b32 v101, 160, v96
    v_xor_b32 v102, 192, v96
    v_xor_b32 v103, 224, v96
    s_lshl_b32 s72, s3, 11
    s_add_u32 s72, s72, 131072
    v_add_u32 v94, s72, v4
    v_pk_mov_b32 v[44:45], 0, 0
    v_pk_mov_b32 v[46:47], 0, 0
    v_pk_mov_b32 v[48:49], 0, 0
    v_pk_mov_b32 v[50:51], 0, 0
    v_pk_mov_b32 v[52:53], 0, 0
    v_pk_mov_b32 v[54:55], 0, 0
    v_pk_mov_b32 v[56:57], 0, 0
    v_pk_mov_b32 v[58:59], 0, 0
    v_pk_mov_b32 v[60:61], 0, 0
    v_pk_mov_b32 v[62:63], 0, 0
    v_pk_mov_b32 v[64:65], 0, 0
    v_pk_mov_b32 v[66:67], 0, 0
    v_pk_mov_b32 v[68:69], 0, 0
    v_pk_mov_b32 v[70:71], 0, 0
    v_pk_mov_b32 v[72:73], 0, 0
    v_pk_mov_b32 v[74:75], 0, 0
    s_setprio 2
    v_and_b32 v6, 15, v1
    v_lshrrev_b32 v7, 4, v1
    v_add_u32 v8, s77, v6
    v_lshlrev_b32 v8, 9, v8
    v_xor_b32 v9, v6, v7
    v_lshl_add_u32 v120, v9, 4, v8
    v_xor_b32 v121, 64, v120
    v_xor_b32 v122, 128, v120
    v_xor_b32 v123, 192, v120
    v_lshlrev_b32 v95, 8, v7
    v_lshl_add_u32 v95, v6, 3, v95
    v_add_u32 v95, 131072, v95
    s_lshr_b32 s72, s5, 2
    s_lshl_b32 s73, s4, 1
    s_add_u32 s72, s72, s73
    s_lshl_b32 s72, s72, 11
    s_add_u32 s72, s72, 131072
    s_bfe_u32 s73, s5, 0x10001
    s_lshl_b32 s74, s4, 3
    s_add_u32 s74, s74, s5
    s_lshl_b32 s74, s74, 5
    s_add_u32 s37, s74, 4096
    s_add_u32 s40, s74, 16384
    v_and_b32 v8, 1, v7
    v_lshrrev_b32 v9, 1, v7
    s_bitcmp1_b32 s5, 0
    s_cbranch_scc1 L_vproj
    s_lshl_b32 s73, s73, 8
    s_add_u32 s72, s72, s73
    v_lshlrev_b32 v124, 9, v8
    v_lshl_add_u32 v124, v6, 4, v124
    v_lshl_add_u32 v124, v9, 3, v124
    s_mov_b32 s75, 1.0
    s_add_u32 s73, s72, 131072
    buffer_load_dword v12, v124, s[8:11], s73 offen
    buffer_load_dword v13, v19, s[8:11], s40 offen
    s_waitcnt vmcnt(2)
    ds_read_b128 v[126:129], v120 offset:0
    ds_read_b64_tr_b16 v[190:191], v95 offset:0
    ds_read_b64_tr_b16 v[192:193], v95 offset:128
    ds_read_b128 v[130:133], v121 offset:0
    ds_read_b64_tr_b16 v[194:195], v95 offset:1024
    ds_read_b64_tr_b16 v[196:197], v95 offset:1152
    ds_read_b128 v[134:137], v122 offset:0
    ds_read_b64_tr_b16 v[198:199], v95 offset:2048
    ds_read_b64_tr_b16 v[200:201], v95 offset:2176
    ds_read_b128 v[138:141], v123 offset:0
    ds_read_b64_tr_b16 v[202:203], v95 offset:3072
    ds_read_b64_tr_b16 v[204:205], v95 offset:3200
    ds_read_b128 v[142:145], v120 offset:256
    ds_read_b64_tr_b16 v[206:207], v95 offset:4096
    ds_read_b64_tr_b16 v[208:209], v95 offset:4224
    s_waitcnt lgkmcnt(12)
    v_mfma_f32_16x16x32_bf16 v[104:107], v[190:193], v[126:129], 0
    ds_read_b128 v[146:149], v121 offset:256
    ds_read_b64_tr_b16 v[210:211], v95 offset:5120
    ds_read_b64_tr_b16 v[212:213], v95 offset:5248
    s_waitcnt lgkmcnt(12)
    v_mfma_f32_16x16x32_bf16 v[108:111], v[194:197], v[130:133], 0
    ds_read_b128 v[150:153], v122 offset:256
    ds_read_b64_tr_b16 v[214:215], v95 offset:6144
    ds_read_b64_tr_b16 v[216:217], v95 offset:6272
    s_waitcnt lgkmcnt(12)
    v_mfma_f32_16x16x32_bf16 v[104:107], v[198:201], v[134:137], v[104:107]
    ds_read_b128 v[154:157], v123 offset:256
    ds_read_b64_tr_b16 v[218:219], v95 offset:7168
    ds_read_b64_tr_b16 v[220:221], v95 offset:7296
    s_waitcnt lgkmcnt(12)
    v_mfma_f32_16x16x32_bf16 v[108:111], v[202:205], v[138:141], v[108:111]
    ds_read_b128 v[158:161], v120 offset:32768
    ds_read_b64_tr_b16 v[222:223], v95 offset:8192
    ds_read_b64_tr_b16 v[224:225], v95 offset:8320
    s_waitcnt lgkmcnt(12)
    v_mfma_f32_16x16x32_bf16 v[104:107], v[206:209], v[142:145], v[104:107]
    ds_read_b128 v[162:165], v121 offset:32768
    ds_read_b64_tr_b16 v[226:227], v95 offset:9216
    ds_read_b64_tr_b16 v[228:229], v95 offset:9344
    s_waitcnt lgkmcnt(12)
    v_mfma_f32_16x16x32_bf16 v[108:111], v[210:213], v[146:149], v[108:111]
    ds_read_b128 v[166:169], v122 offset:32768
    ds_read_b64_tr_b16 v[230:231], v95 offset:10240
    ds_read_b64_tr_b16 v[232:233], v95 offset:10368
    s_waitcnt lgkmcnt(12)
    v_mfma_f32_16x16x32_bf16 v[104:107], v[214:217], v[150:153], v[104:107]
    ds_read_b128 v[170:173], v123 offset:32768
    ds_read_b64_tr_b16 v[234:235], v95 offset:11264
    ds_read_b64_tr_b16 v[236:237], v95 offset:11392
    s_waitcnt lgkmcnt(12)
    v_mfma_f32_16x16x32_bf16 v[108:111], v[218:221], v[154:157], v[108:111]
    ds_read_b128 v[174:177], v120 offset:33024
    ds_read_b64_tr_b16 v[238:239], v95 offset:12288
    ds_read_b64_tr_b16 v[240:241], v95 offset:12416
    s_waitcnt lgkmcnt(12)
    v_mfma_f32_16x16x32_bf16 v[104:107], v[222:225], v[158:161], v[104:107]
    ds_read_b128 v[178:181], v121 offset:33024
    ds_read_b64_tr_b16 v[242:243], v95 offset:13312
    ds_read_b64_tr_b16 v[244:245], v95 offset:13440
    s_waitcnt lgkmcnt(12)
    v_mfma_f32_16x16x32_bf16 v[108:111], v[226:229], v[162:165], v[108:111]
    ds_read_b128 v[182:185], v122 offset:33024
    ds_read_b64_tr_b16 v[246:247], v95 offset:14336
    ds_read_b64_tr_b16 v[248:249], v95 offset:14464
    s_waitcnt lgkmcnt(12)
    v_mfma_f32_16x16x32_bf16 v[104:107], v[230:233], v[166:169], v[104:107]
    ds_read_b128 v[186:189], v123 offset:33024
    ds_read_b64_tr_b16 v[250:251], v95 offset:15360
    ds_read_b64_tr_b16 v[252:253], v95 offset:15488
    s_waitcnt lgkmcnt(12)
    v_mfma_f32_16x16x32_bf16 v[108:111], v[234:237], v[170:173], v[108:111]
    s_waitcnt lgkmcnt(9)
    v_mfma_f32_16x16x32_bf16 v[104:107], v[238:241], v[174:177], v[104:107]
    s_waitcnt lgkmcnt(6)
    v_mfma_f32_16x16x32_bf16 v[108:111], v[242:245], v[178:181], v[108:111]
    s_waitcnt lgkmcnt(3)
    v_mfma_f32_16x16x32_bf16 v[104:107], v[246:249], v[182:185], v[104:107]
    s_waitcnt lgkmcnt(0)
    v_mfma_f32_16x16x32_bf16 v[108:111], v[250:253], v[186:189], v[108:111]
    s_branch L_kvfin
L_vproj:
    s_lshl_b32 s73, s73, 9
    s_add_u32 s72, s72, s73
    s_add_u32 s72, s72, 1024
    v_lshlrev_b32 v124, 8, v9
    v_lshl_add_u32 v124, v6, 4, v124
    v_lshl_add_u32 v124, v8, 3, v124
    s_mov_b32 s75, 1.0
    s_add_u32 s73, s72, 131072
    buffer_load_dword v12, v124, s[8:11], s73 offen
    buffer_load_dword v13, v19, s[8:11], s40 offen
    s_waitcnt vmcnt(2)
    ds_read_b128 v[126:129], v120 offset:0
    ds_read_b64_tr_b16 v[190:191], v95 offset:0
    ds_read_b64_tr_b16 v[192:193], v95 offset:128
    ds_read_b128 v[130:133], v121 offset:0
    ds_read_b64_tr_b16 v[194:195], v95 offset:1024
    ds_read_b64_tr_b16 v[196:197], v95 offset:1152
    ds_read_b128 v[134:137], v122 offset:0
    ds_read_b64_tr_b16 v[198:199], v95 offset:2048
    ds_read_b64_tr_b16 v[200:201], v95 offset:2176
    ds_read_b128 v[138:141], v123 offset:0
    ds_read_b64_tr_b16 v[202:203], v95 offset:3072
    ds_read_b64_tr_b16 v[204:205], v95 offset:3200
    ds_read_b128 v[142:145], v120 offset:256
    ds_read_b64_tr_b16 v[206:207], v95 offset:4096
    ds_read_b64_tr_b16 v[208:209], v95 offset:4224
    s_waitcnt lgkmcnt(12)
    v_mfma_f32_16x16x32_bf16 v[104:107], v[126:129], v[190:193], 0
    ds_read_b128 v[146:149], v121 offset:256
    ds_read_b64_tr_b16 v[210:211], v95 offset:5120
    ds_read_b64_tr_b16 v[212:213], v95 offset:5248
    s_waitcnt lgkmcnt(12)
    v_mfma_f32_16x16x32_bf16 v[108:111], v[130:133], v[194:197], 0
    ds_read_b128 v[150:153], v122 offset:256
    ds_read_b64_tr_b16 v[214:215], v95 offset:6144
    ds_read_b64_tr_b16 v[216:217], v95 offset:6272
    s_waitcnt lgkmcnt(12)
    v_mfma_f32_16x16x32_bf16 v[104:107], v[134:137], v[198:201], v[104:107]
    ds_read_b128 v[154:157], v123 offset:256
    ds_read_b64_tr_b16 v[218:219], v95 offset:7168
    ds_read_b64_tr_b16 v[220:221], v95 offset:7296
    s_waitcnt lgkmcnt(12)
    v_mfma_f32_16x16x32_bf16 v[108:111], v[138:141], v[202:205], v[108:111]
    ds_read_b128 v[158:161], v120 offset:32768
    ds_read_b64_tr_b16 v[222:223], v95 offset:8192
    ds_read_b64_tr_b16 v[224:225], v95 offset:8320
    s_waitcnt lgkmcnt(12)
    v_mfma_f32_16x16x32_bf16 v[104:107], v[142:145], v[206:209], v[104:107]
    ds_read_b128 v[162:165], v121 offset:32768
    ds_read_b64_tr_b16 v[226:227], v95 offset:9216
    ds_read_b64_tr_b16 v[228:229], v95 offset:9344
    s_waitcnt lgkmcnt(12)
    v_mfma_f32_16x16x32_bf16 v[108:111], v[146:149], v[210:213], v[108:111]
    ds_read_b128 v[166:169], v122 offset:32768
    ds_read_b64_tr_b16 v[230:231], v95 offset:10240
    ds_read_b64_tr_b16 v[232:233], v95 offset:10368
    s_waitcnt lgkmcnt(12)
    v_mfma_f32_16x16x32_bf16 v[104:107], v[150:153], v[214:217], v[104:107]
    ds_read_b128 v[170:173], v123 offset:32768
    ds_read_b64_tr_b16 v[234:235], v95 offset:11264
    ds_read_b64_tr_b16 v[236:237], v95 offset:11392
    s_waitcnt lgkmcnt(12)
    v_mfma_f32_16x16x32_bf16 v[108:111], v[154:157], v[218:221], v[108:111]
    ds_read_b128 v[174:177], v120 offset:33024
    ds_read_b64_tr_b16 v[238:239], v95 offset:12288
    ds_read_b64_tr_b16 v[240:241], v95 offset:12416
    s_waitcnt lgkmcnt(12)
    v_mfma_f32_16x16x32_bf16 v[104:107], v[158:161], v[222:225], v[104:107]
    ds_read_b128 v[178:181], v121 offset:33024
    ds_read_b64_tr_b16 v[242:243], v95 offset:13312
    ds_read_b64_tr_b16 v[244:245], v95 offset:13440
    s_waitcnt lgkmcnt(12)
    v_mfma_f32_16x16x32_bf16 v[108:111], v[162:165], v[226:229], v[108:111]
    ds_read_b128 v[182:185], v122 offset:33024
    ds_read_b64_tr_b16 v[246:247], v95 offset:14336
    ds_read_b64_tr_b16 v[248:249], v95 offset:14464
    s_waitcnt lgkmcnt(12)
    v_mfma_f32_16x16x32_bf16 v[104:107], v[166:169], v[230:233], v[104:107]
    ds_read_b128 v[186:189], v123 offset:33024
    ds_read_b64_tr_b16 v[250:251], v95 offset:15360
    ds_read_b64_tr_b16 v[252:253], v95 offset:15488
    s_waitcnt lgkmcnt(12)
    v_mfma_f32_16x16x32_bf16 v[108:111], v[170:173], v[234:237], v[108:111]
    s_waitcnt lgkmcnt(9)
    v_mfma_f32_16x16x32_bf16 v[104:107], v[174:177], v[238:241], v[104:107]
    s_waitcnt lgkmcnt(6)
    v_mfma_f32_16x16x32_bf16 v[108:111], v[178:181], v[242:245], v[108:111]
    s_waitcnt lgkmcnt(3)
    v_mfma_f32_16x16x32_bf16 v[104:107], v[182:185], v[246:249], v[104:107]
    s_waitcnt lgkmcnt(0)
    v_mfma_f32_16x16x32_bf16 v[108:111], v[186:189], v[250:253], v[108:111]
L_kvfin:
    s_nop 7
    v_pk_add_f32 v[104:105], v[104:105], v[108:109]
    v_pk_add_f32 v[106:107], v[106:107], v[110:111]
    v_cvt_pk_bf16_f32 v104, v104, v105
    v_cvt_pk_bf16_f32 v105, v106, v107
    s_add_u32 s73, s72, 131072
    buffer_store_dwordx2 v[104:105], v124, s[8:11], s73 offen
    buffer_store_dwordx2 v[104:105], v124, s[8:11], s72 offen sc1
    s_waitcnt vmcnt(1)
    s_mov_b64 exec, 1
    buffer_store_dword v18, v19, s[8:11], s40 offen
    s_mov_b64 exec, -1
L_b1a:
    s_setprio 1
    s_barrier
    s_add_u32 m0, s46, 32768
    s_add_u32 s39, s47, 262144
    buffer_load_dwordx4 v5, s[52:55], s39 offen lds
    s_add_u32 m0, s46, 33792
    s_add_u32 s39, s47, 270336
    buffer_load_dwordx4 v5, s[52:55], s39 offen lds
    ds_read_b64_tr_b16 v[120:121], v85 offset:0
    ds_read_b64_tr_b16 v[122:123], v85 offset:512
    ds_read_b128 v[144:147], v96 offset:0
    ds_read_b64_tr_b16 v[124:125], v85 offset:2048
    ds_read_b64_tr_b16 v[126:127], v85 offset:2560
    ds_read_b128 v[148:151], v97 offset:0
    ds_read_b64_tr_b16 v[128:129], v85 offset:4096
    ds_read_b64_tr_b16 v[130:131], v85 offset:4608
    ds_read_b128 v[152:155], v98 offset:0
    ds_read_b64_tr_b16 v[132:133], v85 offset:6144
    ds_read_b64_tr_b16 v[134:135], v85 offset:6656
    ds_read_b128 v[156:159], v99 offset:0
    s_waitcnt lgkmcnt(9)
    v_mfma_f32_32x32x16_bf16 v[168:183], v[120:123], v[144:147], 0
    ds_read_b64_tr_b16 v[136:137], v85 offset:8192
    ds_read_b64_tr_b16 v[138:139], v85 offset:8704
    ds_read_b128 v[160:163], v100 offset:0
    s_add_u32 m0, s46, 34816
    s_add_u32 s39, s47, 278528
    buffer_load_dwordx4 v5, s[52:55], s39 offen lds
    s_waitcnt lgkmcnt(9)
    v_mfma_f32_32x32x16_bf16 v[168:183], v[124:127], v[148:151], v[168:183]
    ds_read_b64_tr_b16 v[140:141], v85 offset:10240
    ds_read_b64_tr_b16 v[142:143], v85 offset:10752
    ds_read_b128 v[164:167], v101 offset:0
    s_add_u32 m0, s46, 35840
    s_add_u32 s39, s47, 286720
    buffer_load_dwordx4 v5, s[52:55], s39 offen lds
    s_waitcnt lgkmcnt(9)
    v_mfma_f32_32x32x16_bf16 v[168:183], v[128:131], v[152:155], v[168:183]
    ds_read_b64_tr_b16 v[120:121], v85 offset:12288
    ds_read_b64_tr_b16 v[122:123], v85 offset:12800
    ds_read_b128 v[144:147], v102 offset:0
    s_add_u32 m0, s46, 36864
    s_add_u32 s39, s47, 294912
    buffer_load_dwordx4 v5, s[52:55], s39 offen lds
    s_waitcnt lgkmcnt(9)
    v_mfma_f32_32x32x16_bf16 v[168:183], v[132:135], v[156:159], v[168:183]
    ds_read_b64_tr_b16 v[124:125], v85 offset:14336
    ds_read_b64_tr_b16 v[126:127], v85 offset:14848
    ds_read_b128 v[148:151], v103 offset:0
    s_add_u32 m0, s46, 37888
    s_add_u32 s39, s47, 303104
    buffer_load_dwordx4 v5, s[52:55], s39 offen lds
    s_waitcnt lgkmcnt(9)
    v_mfma_f32_32x32x16_bf16 v[168:183], v[136:139], v[160:163], v[168:183]
    ds_read_b64_tr_b16 v[128:129], v85 offset:16384
    ds_read_b64_tr_b16 v[130:131], v85 offset:16896
    ds_read_b128 v[152:155], v96 offset:256
    s_add_u32 m0, s46, 38912
    s_add_u32 s39, s47, 311296
    buffer_load_dwordx4 v5, s[52:55], s39 offen lds
    s_waitcnt lgkmcnt(9)
    v_mfma_f32_32x32x16_bf16 v[168:183], v[140:143], v[164:167], v[168:183]
    ds_read_b64_tr_b16 v[132:133], v85 offset:18432
    ds_read_b64_tr_b16 v[134:135], v85 offset:18944
    ds_read_b128 v[156:159], v97 offset:256
    s_add_u32 m0, s46, 39936
    s_add_u32 s39, s47, 319488
    buffer_load_dwordx4 v5, s[52:55], s39 offen lds
    s_waitcnt lgkmcnt(9)
    v_mfma_f32_32x32x16_bf16 v[168:183], v[120:123], v[144:147], v[168:183]
    ds_read_b64_tr_b16 v[136:137], v85 offset:20480
    ds_read_b64_tr_b16 v[138:139], v85 offset:20992
    ds_read_b128 v[160:163], v98 offset:256
    s_waitcnt lgkmcnt(9)
    v_mfma_f32_32x32x16_bf16 v[168:183], v[124:127], v[148:151], v[168:183]
    ds_read_b64_tr_b16 v[140:141], v85 offset:22528
    ds_read_b64_tr_b16 v[142:143], v85 offset:23040
    ds_read_b128 v[164:167], v99 offset:256
    s_waitcnt lgkmcnt(9)
    v_mfma_f32_32x32x16_bf16 v[168:183], v[128:131], v[152:155], v[168:183]
    ds_read_b64_tr_b16 v[120:121], v85 offset:24576
    ds_read_b64_tr_b16 v[122:123], v85 offset:25088
    ds_read_b128 v[144:147], v100 offset:256
    s_waitcnt lgkmcnt(9)
    v_mfma_f32_32x32x16_bf16 v[168:183], v[132:135], v[156:159], v[168:183]
    ds_read_b64_tr_b16 v[124:125], v85 offset:26624
    ds_read_b64_tr_b16 v[126:127], v85 offset:27136
    ds_read_b128 v[148:151], v101 offset:256
    s_waitcnt lgkmcnt(9)
    v_mfma_f32_32x32x16_bf16 v[168:183], v[136:139], v[160:163], v[168:183]
    ds_read_b64_tr_b16 v[128:129], v85 offset:28672
    ds_read_b64_tr_b16 v[130:131], v85 offset:29184
    ds_read_b128 v[152:155], v102 offset:256
    s_waitcnt lgkmcnt(9)
    v_mfma_f32_32x32x16_bf16 v[168:183], v[140:143], v[164:167], v[168:183]
    ds_read_b64_tr_b16 v[132:133], v85 offset:30720
    ds_read_b64_tr_b16 v[134:135], v85 offset:31232
    ds_read_b128 v[156:159], v103 offset:256
    s_cmp_lg_u32 s3, 0
    s_cbranch_scc1 L_nof1
    s_waitcnt vmcnt(9)
    s_mov_b64 exec, 1
    buffer_store_dword v11, v19, s[8:11], s37 offen sc1
    s_mov_b64 exec, -1
L_nof1:
    s_waitcnt lgkmcnt(9)
    v_mfma_f32_32x32x16_bf16 v[168:183], v[120:123], v[144:147], v[168:183]
    s_waitcnt lgkmcnt(6)
    v_mfma_f32_32x32x16_bf16 v[168:183], v[124:127], v[148:151], v[168:183]
    s_waitcnt lgkmcnt(3)
    v_mfma_f32_32x32x16_bf16 v[168:183], v[128:131], v[152:155], v[168:183]
    s_waitcnt lgkmcnt(0)
    v_mfma_f32_32x32x16_bf16 v[168:183], v[132:135], v[156:159], v[168:183]
    s_cmp_lg_u32 s3, 0
    s_cbranch_scc1 L_wall
    s_waitcnt vmcnt(1)
    s_branch L_b1b
L_wall:
    s_waitcnt vmcnt(0)
L_b1b:
    s_barrier
    s_mov_b64 exec, 0xff
    ds_write_b32 v37, v38 offset:2048
    s_mov_b64 exec, -1
    ds_read_b64_tr_b16 v[136:137], v85 offset:32768
    ds_read_b64_tr_b16 v[138:139], v85 offset:33280
    ds_read_b128 v[160:163], v96 offset:32768
    ds_read_b64_tr_b16 v[140:141], v85 offset:34816
    ds_read_b64_tr_b16 v[142:143], v85 offset:35328
    ds_read_b128 v[164:167], v97 offset:32768
    ds_read_b64_tr_b16 v[120:121], v85 offset:36864
    ds_read_b64_tr_b16 v[122:123], v85 offset:37376
    ds_read_b128 v[144:147], v98 offset:32768
    ds_read_b64_tr_b16 v[124:125], v85 offset:38912
    ds_read_b64_tr_b16 v[126:127], v85 offset:39424
    ds_read_b128 v[148:151], v99 offset:32768
    s_waitcnt lgkmcnt(9)
    v_mfma_f32_32x32x16_bf16 v[168:183], v[136:139], v[160:163], v[168:183]
    ds_read_b64_tr_b16 v[128:129], v85 offset:40960
    ds_read_b64_tr_b16 v[130:131], v85 offset:41472
    ds_read_b128 v[152:155], v100 offset:32768
    s_waitcnt lgkmcnt(9)
    v_mfma_f32_32x32x16_bf16 v[168:183], v[140:143], v[164:167], v[168:183]
    ds_read_b64_tr_b16 v[132:133], v85 offset:43008
    ds_read_b64_tr_b16 v[134:135], v85 offset:43520
    ds_read_b128 v[156:159], v101 offset:32768
    s_waitcnt lgkmcnt(9)
    v_mfma_f32_32x32x16_bf16 v[168:183], v[120:123], v[144:147], v[168:183]
    ds_read_b64_tr_b16 v[136:137], v85 offset:45056
    ds_read_b64_tr_b16 v[138:139], v85 offset:45568
    ds_read_b128 v[160:163], v102 offset:32768
    s_waitcnt lgkmcnt(9)
    v_mfma_f32_32x32x16_bf16 v[168:183], v[124:127], v[148:151], v[168:183]
    ds_read_b64_tr_b16 v[140:141], v85 offset:47104
    ds_read_b64_tr_b16 v[142:143], v85 offset:47616
    ds_read_b128 v[164:167], v103 offset:32768
    s_waitcnt lgkmcnt(9)
    v_mfma_f32_32x32x16_bf16 v[168:183], v[128:131], v[152:155], v[168:183]
    ds_read_b64_tr_b16 v[120:121], v85 offset:49152
    ds_read_b64_tr_b16 v[122:123], v85 offset:49664
    ds_read_b128 v[144:147], v96 offset:33024
    s_waitcnt lgkmcnt(9)
    v_mfma_f32_32x32x16_bf16 v[168:183], v[132:135], v[156:159], v[168:183]
    ds_read_b64_tr_b16 v[124:125], v85 offset:51200
    ds_read_b64_tr_b16 v[126:127], v85 offset:51712
    ds_read_b128 v[148:151], v97 offset:33024
    s_waitcnt lgkmcnt(9)
    v_mfma_f32_32x32x16_bf16 v[168:183], v[136:139], v[160:163], v[168:183]
    ds_read_b64_tr_b16 v[128:129], v85 offset:53248
    ds_read_b64_tr_b16 v[130:131], v85 offset:53760
    ds_read_b128 v[152:155], v98 offset:33024
    s_waitcnt lgkmcnt(9)
    v_mfma_f32_32x32x16_bf16 v[168:183], v[140:143], v[164:167], v[168:183]
    ds_read_b64_tr_b16 v[132:133], v85 offset:55296
    ds_read_b64_tr_b16 v[134:135], v85 offset:55808
    ds_read_b128 v[156:159], v99 offset:33024
    s_waitcnt lgkmcnt(9)
    v_mfma_f32_32x32x16_bf16 v[168:183], v[120:123], v[144:147], v[168:183]
    ds_read_b64_tr_b16 v[136:137], v85 offset:57344
    ds_read_b64_tr_b16 v[138:139], v85 offset:57856
    ds_read_b128 v[160:163], v100 offset:33024
    s_waitcnt lgkmcnt(9)
    v_mfma_f32_32x32x16_bf16 v[168:183], v[124:127], v[148:151], v[168:183]
    ds_read_b64_tr_b16 v[140:141], v85 offset:59392
    ds_read_b64_tr_b16 v[142:143], v85 offset:59904
    ds_read_b128 v[164:167], v101 offset:33024
    s_waitcnt lgkmcnt(9)
    v_mfma_f32_32x32x16_bf16 v[168:183], v[128:131], v[152:155], v[168:183]
    ds_read_b64_tr_b16 v[120:121], v85 offset:61440
    ds_read_b64_tr_b16 v[122:123], v85 offset:61952
    ds_read_b128 v[144:147], v102 offset:33024
    s_waitcnt lgkmcnt(9)
    v_mfma_f32_32x32x16_bf16 v[168:183], v[132:135], v[156:159], v[168:183]
    ds_read_b64_tr_b16 v[124:125], v85 offset:63488
    ds_read_b64_tr_b16 v[126:127], v85 offset:64000
    ds_read_b128 v[148:151], v103 offset:33024
    s_waitcnt lgkmcnt(9)
    v_mfma_f32_32x32x16_bf16 v[168:183], v[136:139], v[160:163], v[168:183]
    s_waitcnt lgkmcnt(6)
    v_mfma_f32_32x32x16_bf16 v[168:183], v[140:143], v[164:167], v[168:183]
    s_waitcnt lgkmcnt(3)
    v_mfma_f32_32x32x16_bf16 v[168:183], v[120:123], v[144:147], v[168:183]
    s_waitcnt lgkmcnt(0)
    v_mfma_f32_32x32x16_bf16 v[168:183], v[124:127], v[148:151], v[168:183]
    buffer_load_dword v84, v21, s[8:11], 0 offen sc1
    s_setprio 3
    s_mov_b32 s74, 0x3eb8aa3b
    s_mov_b32 s75, s74
    s_nop 7
    v_mul_f32 v168, s74, v168
    v_mul_f32 v169, s74, v169
    v_mul_f32 v170, s74, v170
    v_mul_f32 v171, s74, v171
    v_cvt_pk_bf16_f32 v76, v168, v169
    v_mul_f32 v172, s74, v172
    v_mul_f32 v173, s74, v173
    v_cvt_pk_bf16_f32 v77, v170, v171
    v_mul_f32 v174, s74, v174
    v_mul_f32 v175, s74, v175
    v_cvt_pk_bf16_f32 v78, v172, v173
    v_mul_f32 v176, s74, v176
    v_mul_f32 v177, s74, v177
    v_cvt_pk_bf16_f32 v79, v174, v175
    ds_write_b128 v94, v[76:79]
    v_mul_f32 v178, s74, v178
    v_mul_f32 v179, s74, v179
    v_cvt_pk_bf16_f32 v80, v176, v177
    v_mul_f32 v180, s74, v180
    v_mul_f32 v181, s74, v181
    v_cvt_pk_bf16_f32 v81, v178, v179
    v_mul_f32 v182, s74, v182
    v_mul_f32 v183, s74, v183
    v_cvt_pk_bf16_f32 v82, v180, v181
    v_cvt_pk_bf16_f32 v83, v182, v183
    ds_write_b128 v94, v[80:83] offset:1024
    s_waitcnt lgkmcnt(0)
    s_barrier
    s_setprio 0
    s_branch L_b2
L_kgen:
    s_bitcmp1_b32 s3, 1
    s_cselect_b32 s72, 0, 16
    s_lshl_b32 s72, s80, s72
    s_and_b32 s72, s72, 0xffff0000
    v_mov_b32 v85, 0x3fb8aa3b
    v_mul_f32 v85, s72, v85
    v_exp_f32 v85, v85
    s_nop 0
    v_cvt_pk_bf16_f32 v85, v85, v85
    v_and_b32 v85, 0xffff0000, v85
    v_lshlrev_b32 v6, 2, v3
    v_sub_u32 v6, v2, v6
    v_and_b32 v7, 1, v6
    v_lshlrev_b32 v7, 4, v7
    v_mov_b32 v8, 0x3f80
    v_lshlrev_b32 v7, v7, v8
    v_lshrrev_b32 v6, 1, v6
    v_cmp_eq_u32 s[78:79], 0, v6
    s_nop 1
    v_cndmask_b32 v110, 0, v7, s[78:79]
    v_cmp_eq_u32 s[78:79], 1, v6
    s_nop 1
    v_cndmask_b32 v111, 0, v7, s[78:79]
    v_cmp_eq_u32 s[78:79], 4, v6
    s_nop 1
    v_cndmask_b32 v112, 0, v7, s[78:79]
    v_cmp_eq_u32 s[78:79], 5, v6
    s_nop 1
    v_cndmask_b32 v113, 0, v7, s[78:79]
    v_cmp_eq_u32 s[78:79], 8, v6
    s_nop 1
    v_cndmask_b32 v114, 0, v7, s[78:79]
    v_cmp_eq_u32 s[78:79], 9, v6
    s_nop 1
    v_cndmask_b32 v115, 0, v7, s[78:79]
    v_cmp_eq_u32 s[78:79], 12, v6
    s_nop 1
    v_cndmask_b32 v116, 0, v7, s[78:79]
    v_cmp_eq_u32 s[78:79], 13, v6
    s_nop 1
    v_cndmask_b32 v117, 0, v7, s[78:79]
    v_mov_b32 v118, 1.0
    v_mov_b32 v119, 0
    v_mov_b32 v120, 1.0
    v_mov_b32 v121, 0
    s_waitcnt vmcnt(2)
L_w3:
    v_lshlrev_b32 v12, 16, v12
    v_lshlrev_b32 v13, 16, v13
    v_lshlrev_b32 v14, 16, v14
    v_lshlrev_b32 v15, 16, v15
    v_lshlrev_b32 v16, 16, v16
    v_lshlrev_b32 v17, 16, v17
    v_mul_f32 v12, v85, v12
    v_mul_f32 v13, v85, v13
    v_mul_f32 v14, v85, v14
    v_mul_f32 v15, v85, v15
    v_mul_f32 v122, 0x3fb8aa3b, v12
    v_mul_f32 v123, 0x3e22f983, v13
    v_mul_f32 v124, v16, v14
    v_mul_f32 v125, v16, v15
    v_fma_f32 v124, -v17, v15, v124
    v_fmac_f32 v125, v17, v14
    v_fract_f32 v127, v123
    v_exp_f32 v126, v122
    v_cos_f32 v128, v127
    v_sin_f32 v129, v127
    v_mul_f32 v130, v128, v126
    v_mul_f32 v131, v129, v126
    v_mul_f32 v126, 0x41000000, v122
    v_mul_f32 v127, 0x41000000, v123
    v_fract_f32 v127, v127
    v_exp_f32 v126, v126
    v_cos_f32 v128, v127
    v_sin_f32 v129, v127
    v_mul_f32 v132, v128, v126
    v_mul_f32 v133, v129, v126
    v_mul_f32 v126, 0x42800000, v122
    v_mul_f32 v127, 0x42800000, v123
    v_fract_f32 v127, v127
    v_exp_f32 v126, v126
    v_cos_f32 v128, v127
    v_sin_f32 v129, v127
    v_mul_f32 v134, v128, v126
    v_mul_f32 v135, v129, v126
    v_mul_f32 v126, 0x43800000, v122
    v_mul_f32 v127, 0x43800000, v123
    v_fract_f32 v127, v127
    v_exp_f32 v126, v126
    v_cos_f32 v128, v127
    v_sin_f32 v129, v127
    v_mul_f32 v136, v128, v126
    v_mul_f32 v137, v129, v126
    v_mul_f32 v138, v130, v130
    v_mul_f32 v139, v130, v131
    v_fma_f32 v138, -v131, v131, v138
    v_fmac_f32 v139, v131, v130
    v_mul_f32 v140, v132, v132
    v_mul_f32 v141, v132, v133
    v_fma_f32 v140, -v133, v133, v140
    v_fmac_f32 v141, v133, v132
    v_mul_f32 v142, v136, v136
    v_mul_f32 v143, v136, v137
    v_fma_f32 v142, -v137, v137, v142
    v_fmac_f32 v143, v137, v136
    v_mul_f32 v144, v138, v138
    v_mul_f32 v145, v138, v139
    v_fma_f32 v144, -v139, v139, v144
    v_fmac_f32 v145, v139, v138
    v_mul_f32 v146, v140, v140
    v_mul_f32 v147, v140, v141
    v_fma_f32 v146, -v141, v141, v146
    v_fmac_f32 v147, v141, v140
    v_mul_f32 v148, v142, v136
    v_mul_f32 v149, v142, v137
    v_fma_f32 v148, -v143, v137, v148
    v_fmac_f32 v149, v143, v136
    v_mul_f32 v150, v124, v136
    v_mul_f32 v151, v124, v137
    v_fma_f32 v150, -v125, v137, v150
    v_fmac_f32 v151, v125, v136
    v_mul_f32 v152, v124, v142
    v_mul_f32 v153, v124, v143
    v_fma_f32 v152, -v125, v143, v152
    v_fmac_f32 v153, v125, v142
    v_mul_f32 v154, v124, v148
    v_mul_f32 v155, v124, v149
    v_fma_f32 v154, -v125, v149, v154
    v_fmac_f32 v155, v125, v148
    v_mov_b32 v156, v130
    v_mov_b32 v157, v131
    v_mov_b32 v158, v144
    v_mov_b32 v159, v145
    v_mov_b32 v160, v132
    v_mov_b32 v161, v133
    v_mov_b32 v162, v134
    v_mov_b32 v163, v135
    v_mov_b32 v164, v136
    v_mov_b32 v165, v137
    v_permlane32_swap_b32 v124, v150
    v_permlane32_swap_b32 v125, v151
    v_permlane32_swap_b32 v130, v118
    v_permlane32_swap_b32 v131, v119
    v_permlane32_swap_b32 v156, v138
    v_permlane32_swap_b32 v157, v139
    v_permlane32_swap_b32 v152, v154
    v_permlane32_swap_b32 v153, v155
    v_permlane32_swap_b32 v142, v148
    v_permlane32_swap_b32 v143, v149
    v_permlane32_swap_b32 v144, v158
    v_permlane32_swap_b32 v145, v159
    v_permlane32_swap_b32 v132, v160
    v_permlane32_swap_b32 v133, v161
    v_permlane32_swap_b32 v136, v164
    v_permlane32_swap_b32 v137, v165
    v_permlane32_swap_b32 v134, v162
    v_permlane32_swap_b32 v135, v163
    v_permlane32_swap_b32 v120, v146
    v_permlane32_swap_b32 v121, v147
    s_lshl_b32 s72, s3, 2
    s_add_u32 s72, s72, 163648
    v_mov_b32 v127, s72
    ds_write_b32 v127, v19
    s_and_b32 s72, s2, 7
    s_lshl_b32 s72, s72, 3
    s_add_u32 s72, s72, s3
    s_sub_u32 s72, s72, 4
    v_bfe_u32 v6, v1, 2, 1
    v_lshl_add_u32 v6, v6, 2, s72
    v_and_b32 v7, 3, v1
    v_lshl_add_u32 v6, v6, 2, v7
    v_lshlrev_b32 v6, 5, v6
    v_mul_u32_u24 v7, 12288, v3
    v_sub_u32 v85, v6, v7
    v_add_u32 v85, 16384, v85
    v_cmp_gt_u32 s[78:79], 32, v1
    s_nop 1
    v_cndmask_b32 v122, v11, v18, s[78:79]
    v_not_b32 v84, v122
    s_lshl_b32 s38, s72, 11
    s_mov_b32 s82, 400000
    v_lshlrev_b32 v126, 10, v34
    s_lshl_b32 s72, s4, 16
    s_lshl_b32 s73, s5, 7
    s_add_u32 s72, s72, s73
    s_sub_u32 s73, s3, 4
    s_lshl_b32 s73, s73, 5
    s_add_u32 s72, s72, s73
    s_bfe_u32 s74, s3, 0x10001
    s_lshl_b32 s74, s74, 12
    s_add_u32 s74, s74, 139264
    v_add_u32 v123, s74, v4
    v_mul_f32 v168, v124, v130
    v_mul_f32 v169, v124, v131
    v_fma_f32 v168, -v125, v131, v168
    v_fmac_f32 v169, v125, v130
    v_mul_f32 v184, v152, v144
    v_mul_f32 v185, v152, v145
    v_fma_f32 v184, -v153, v145, v184
    v_fmac_f32 v185, v153, v144
    v_mul_f32 v188, v152, v142
    v_mul_f32 v189, v152, v143
    v_fma_f32 v188, -v153, v143, v188
    v_fmac_f32 v189, v153, v142
    v_mul_f32 v170, v168, v156
    v_mul_f32 v171, v168, v157
    v_fma_f32 v170, -v169, v157, v170
    v_fmac_f32 v171, v169, v156
    v_mul_f32 v186, v184, v144
    v_mul_f32 v187, v184, v145
    v_fma_f32 v186, -v185, v145, v186
    v_fmac_f32 v187, v185, v144
    v_mul_f32 v190, v188, v132
    v_mul_f32 v191, v188, v133
    v_fma_f32 v190, -v189, v133, v190
    v_fmac_f32 v191, v189, v132
    v_mul_f32 v172, v170, v156
    v_mul_f32 v173, v170, v157
    v_fma_f32 v172, -v171, v157, v172
    v_fmac_f32 v173, v171, v156
    v_mul_f32 v192, v188, v136
    v_mul_f32 v193, v188, v137
    v_fma_f32 v192, -v189, v137, v192
    v_fmac_f32 v193, v189, v136
    v_mul_f32 v174, v172, v130
    v_mul_f32 v175, v172, v131
    v_fma_f32 v174, -v173, v131, v174
    v_fmac_f32 v175, v173, v130
    v_mul_f32 v194, v192, v132
    v_mul_f32 v195, v192, v133
    v_fma_f32 v194, -v193, v133, v194
    v_fmac_f32 v195, v193, v132
    v_mul_f32 v176, v174, v130
    v_mul_f32 v177, v174, v131
    v_fma_f32 v176, -v175, v131, v176
    v_fmac_f32 v177, v175, v130
    v_mul_f32 v178, v176, v156
    v_mul_f32 v179, v176, v157
    v_fma_f32 v178, -v177, v157, v178
    v_fmac_f32 v179, v177, v156
    v_mul_f32 v180, v178, v156
    v_mul_f32 v181, v178, v157
    v_fma_f32 v180, -v179, v157, v180
    v_fmac_f32 v181, v179, v156
    v_cvt_pk_bf16_f32 v198, v124, v168
    v_cvt_pk_bf16_f32 v206, -v125, -v169
    v_cvt_pk_bf16_f32 v199, v170, v172
    v_cvt_pk_bf16_f32 v207, -v171, -v173
    v_cvt_pk_bf16_f32 v200, v174, v176
    v_cvt_pk_bf16_f32 v208, -v175, -v177
    v_cvt_pk_bf16_f32 v201, v178, v180
    v_cvt_pk_bf16_f32 v209, -v179, -v181
    v_cvt_pk_bf16_f32 v202, v152, v184
    v_cvt_pk_bf16_f32 v210, -v153, -v185
    v_cvt_pk_bf16_f32 v203, v186, v188
    v_cvt_pk_bf16_f32 v211, -v187, -v189
    v_cvt_pk_bf16_f32 v204, v190, v192
    v_cvt_pk_bf16_f32 v212, -v191, -v193
    v_cvt_pk_bf16_f32 v205, v194, v194
    v_cvt_pk_bf16_f32 v213, -v195, -v195
    v_mfma_f32_32x32x16_bf16 v[44:59], v[198:201], v[110:113], 0
    v_mul_f32 v168, v120, v132
    v_mul_f32 v169, v120, v133
    v_fma_f32 v168, -v121, v133, v168
    v_fmac_f32 v169, v121, v132
    v_mul_f32 v170, v168, v132
    v_mul_f32 v171, v168, v133
    v_fma_f32 v170, -v169, v133, v170
    v_fmac_f32 v171, v169, v132
    v_mfma_f32_32x32x16_bf16 v[60:75], v[206:209], v[110:113], 0
    v_mul_f32 v172, v170, v132
    v_mul_f32 v173, v170, v133
    v_fma_f32 v172, -v171, v133, v172
    v_fmac_f32 v173, v171, v132
    v_mul_f32 v174, v120, v134
    v_mul_f32 v175, v120, v135
    v_fma_f32 v174, -v121, v135, v174
    v_fmac_f32 v175, v121, v134
    v_mfma_f32_32x32x16_bf16 v[44:59], v[202:205], v[114:117], v[44:59]
    v_mul_f32 v176, v168, v134
    v_mul_f32 v177, v168, v135
    v_fma_f32 v176, -v169, v135, v176
    v_fmac_f32 v177, v169, v134
    v_mul_f32 v178, v170, v134
    v_mul_f32 v179, v170, v135
    v_fma_f32 v178, -v171, v135, v178
    v_fmac_f32 v179, v171, v134
    v_mfma_f32_32x32x16_bf16 v[60:75], v[210:213], v[114:117], v[60:75]
    v_mul_f32 v180, v172, v134
    v_mul_f32 v181, v172, v135
    v_fma_f32 v180, -v173, v135, v180
    v_fmac_f32 v181, v173, v134
    v_mul_f32 v182, v174, v134
    v_mul_f32 v183, v174, v135
    v_fma_f32 v182, -v175, v135, v182
    v_fmac_f32 v183, v175, v134
    v_mul_f32 v184, v176, v134
    v_mul_f32 v185, v176, v135
    v_fma_f32 v184, -v177, v135, v184
    v_fmac_f32 v185, v177, v134
    v_mul_f32 v186, v178, v134
    v_mul_f32 v187, v178, v135
    v_fma_f32 v186, -v179, v135, v186
    v_fmac_f32 v187, v179, v134
    v_mul_f32 v188, v180, v134
    v_mul_f32 v189, v180, v135
    v_fma_f32 v188, -v181, v135, v188
    v_fmac_f32 v189, v181, v134
    v_mul_f32 v190, v182, v134
    v_mul_f32 v191, v182, v135
    v_fma_f32 v190, -v183, v135, v190
    v_fmac_f32 v191, v183, v134
    v_mul_f32 v192, v184, v134
    v_mul_f32 v193, v184, v135
    v_fma_f32 v192, -v185, v135, v192
    v_fmac_f32 v193, v185, v134
    v_mul_f32 v194, v186, v134
    v_mul_f32 v195, v186, v135
    v_fma_f32 v194, -v187, v135, v194
    v_fmac_f32 v195, v187, v134
    v_mul_f32 v196, v188, v134
    v_mul_f32 v197, v188, v135
    v_fma_f32 v196, -v189, v135, v196
    v_fmac_f32 v197, v189, v134
    v_cvt_pk_bf16_f32 v198, v120, v168
    v_cvt_pk_bf16_f32 v206, v121, v169
    v_cvt_pk_bf16_f32 v199, v170, v172
    v_cvt_pk_bf16_f32 v207, v171, v173
    v_cvt_pk_bf16_f32 v200, v174, v176
    v_cvt_pk_bf16_f32 v208, v175, v177
    v_cvt_pk_bf16_f32 v201, v178, v180
    v_cvt_pk_bf16_f32 v209, v179, v181
    v_cvt_pk_bf16_f32 v202, v182, v184
    v_cvt_pk_bf16_f32 v210, v183, v185
    v_cvt_pk_bf16_f32 v203, v186, v188
    v_cvt_pk_bf16_f32 v211, v187, v189
    v_cvt_pk_bf16_f32 v204, v190, v192
    v_cvt_pk_bf16_f32 v212, v191, v193
    v_cvt_pk_bf16_f32 v205, v194, v196
    v_cvt_pk_bf16_f32 v213, v195, v197
    v_cvt_pk_bf16_f32 v214, v44, v45
    v_cvt_pk_bf16_f32 v215, v46, v47
    v_cvt_pk_bf16_f32 v216, v48, v49
    v_cvt_pk_bf16_f32 v217, v50, v51
    v_cvt_pk_bf16_f32 v218, v52, v53
    v_cvt_pk_bf16_f32 v219, v54, v55
    v_cvt_pk_bf16_f32 v220, v56, v57
    v_cvt_pk_bf16_f32 v221, v58, v59
    v_cvt_pk_bf16_f32 v222, v60, v61
    v_cvt_pk_bf16_f32 v223, v62, v63
    v_cvt_pk_bf16_f32 v224, v64, v65
    v_cvt_pk_bf16_f32 v225, v66, v67
    v_cvt_pk_bf16_f32 v226, v68, v69
    v_cvt_pk_bf16_f32 v227, v70, v71
    v_cvt_pk_bf16_f32 v228, v72, v73
    v_cvt_pk_bf16_f32 v229, v74, v75
    v_mfma_f32_32x32x16_bf16 v[44:59], v[198:201], v[110:113], 0
    v_mul_f32 v168, v150, v118
    v_mul_f32 v169, v150, v119
    v_fma_f32 v168, -v151, v119, v168
    v_fmac_f32 v169, v151, v118
    v_mul_f32 v184, v154, v158
    v_mul_f32 v185, v154, v159
    v_fma_f32 v184, -v155, v159, v184
    v_fmac_f32 v185, v155, v158
    v_mfma_f32_32x32x16_bf16 v[60:75], v[206:209], v[110:113], 0
    v_mul_f32 v188, v154, v148
    v_mul_f32 v189, v154, v149
    v_fma_f32 v188, -v155, v149, v188
    v_fmac_f32 v189, v155, v148
    v_mul_f32 v170, v168, v138
    v_mul_f32 v171, v168, v139
    v_fma_f32 v170, -v169, v139, v170
    v_fmac_f32 v171, v169, v138
    v_mfma_f32_32x32x16_bf16 v[44:59], v[202:205], v[114:117], v[44:59]
    v_mul_f32 v186, v184, v158
    v_mul_f32 v187, v184, v159
    v_fma_f32 v186, -v185, v159, v186
    v_fmac_f32 v187, v185, v158
    v_mul_f32 v190, v188, v160
    v_mul_f32 v191, v188, v161
    v_fma_f32 v190, -v189, v161, v190
    v_fmac_f32 v191, v189, v160
    v_mfma_f32_32x32x16_bf16 v[60:75], v[210:213], v[114:117], v[60:75]
    v_mul_f32 v172, v170, v138
    v_mul_f32 v173, v170, v139
    v_fma_f32 v172, -v171, v139, v172
    v_fmac_f32 v173, v171, v138
    v_mul_f32 v192, v188, v164
    v_mul_f32 v193, v188, v165
    v_fma_f32 v192, -v189, v165, v192
    v_fmac_f32 v193, v189, v164
    v_mul_f32 v174, v172, v118
    v_mul_f32 v175, v172, v119
    v_fma_f32 v174, -v173, v119, v174
    v_fmac_f32 v175, v173, v118
    v_mul_f32 v194, v192, v160
    v_mul_f32 v195, v192, v161
    v_fma_f32 v194, -v193, v161, v194
    v_fmac_f32 v195, v193, v160
    v_mul_f32 v176, v174, v118
    v_mul_f32 v177, v174, v119
    v_fma_f32 v176, -v175, v119, v176
    v_fmac_f32 v177, v175, v118
    v_mul_f32 v178, v176, v138
    v_mul_f32 v179, v176, v139
    v_fma_f32 v178, -v177, v139, v178
    v_fmac_f32 v179, v177, v138
    v_mul_f32 v180, v178, v138
    v_mul_f32 v181, v178, v139
    v_fma_f32 v180, -v179, v139, v180
    v_fmac_f32 v181, v179, v138
    v_cvt_pk_bf16_f32 v198, v150, v168
    v_cvt_pk_bf16_f32 v206, -v151, -v169
    v_cvt_pk_bf16_f32 v199, v170, v172
    v_cvt_pk_bf16_f32 v207, -v171, -v173
    v_cvt_pk_bf16_f32 v200, v174, v176
    v_cvt_pk_bf16_f32 v208, -v175, -v177
    v_cvt_pk_bf16_f32 v201, v178, v180
    v_cvt_pk_bf16_f32 v209, -v179, -v181
    v_cvt_pk_bf16_f32 v202, v154, v184
    v_cvt_pk_bf16_f32 v210, -v155, -v185
    v_cvt_pk_bf16_f32 v203, v186, v188
    v_cvt_pk_bf16_f32 v211, -v187, -v189
    v_cvt_pk_bf16_f32 v204, v190, v192
    v_cvt_pk_bf16_f32 v212, -v191, -v193
    v_cvt_pk_bf16_f32 v205, v194, v194
    v_cvt_pk_bf16_f32 v213, -v195, -v195
    v_cvt_pk_bf16_f32 v230, v44, v45
    v_cvt_pk_bf16_f32 v231, v46, v47
    v_cvt_pk_bf16_f32 v232, v48, v49
    v_cvt_pk_bf16_f32 v233, v50, v51
    v_cvt_pk_bf16_f32 v234, v52, v53
    v_cvt_pk_bf16_f32 v235, v54, v55
    v_cvt_pk_bf16_f32 v236, v56, v57
    v_cvt_pk_bf16_f32 v237, v58, v59
    v_cvt_pk_bf16_f32 v238, v60, v61
    v_cvt_pk_bf16_f32 v239, v62, v63
    v_cvt_pk_bf16_f32 v240, v64, v65
    v_cvt_pk_bf16_f32 v241, v66, v67
    v_cvt_pk_bf16_f32 v242, v68, v69
    v_cvt_pk_bf16_f32 v243, v70, v71
    v_cvt_pk_bf16_f32 v244, v72, v73
    v_cvt_pk_bf16_f32 v245, v74, v75
    v_mfma_f32_32x32x16_bf16 v[44:59], v[198:201], v[110:113], 0
    v_mul_f32 v168, v146, v160
    v_mul_f32 v169, v146, v161
    v_fma_f32 v168, -v147, v161, v168
    v_fmac_f32 v169, v147, v160
    v_mul_f32 v170, v168, v160
    v_mul_f32 v171, v168, v161
    v_fma_f32 v170, -v169, v161, v170
    v_fmac_f32 v171, v169, v160
    v_mfma_f32_32x32x16_bf16 v[60:75], v[206:209], v[110:113], 0
    v_mul_f32 v172, v170, v160
    v_mul_f32 v173, v170, v161
    v_fma_f32 v172, -v171, v161, v172
    v_fmac_f32 v173, v171, v160
    v_mul_f32 v174, v146, v162
    v_mul_f32 v175, v146, v163
    v_fma_f32 v174, -v147, v163, v174
    v_fmac_f32 v175, v147, v162
    v_mfma_f32_32x32x16_bf16 v[44:59], v[202:205], v[114:117], v[44:59]
    v_mul_f32 v176, v168, v162
    v_mul_f32 v177, v168, v163
    v_fma_f32 v176, -v169, v163, v176
    v_fmac_f32 v177, v169, v162
    v_mul_f32 v178, v170, v162
    v_mul_f32 v179, v170, v163
    v_fma_f32 v178, -v171, v163, v178
    v_fmac_f32 v179, v171, v162
    v_mfma_f32_32x32x16_bf16 v[60:75], v[210:213], v[114:117], v[60:75]
    v_mul_f32 v180, v172, v162
    v_mul_f32 v181, v172, v163
    v_fma_f32 v180, -v173, v163, v180
    v_fmac_f32 v181, v173, v162
    v_mul_f32 v182, v174, v162
    v_mul_f32 v183, v174, v163
    v_fma_f32 v182, -v175, v163, v182
    v_fmac_f32 v183, v175, v162
    v_mfma_f32_32x32x16_bf16 v[94:109], v[214:217], v[230:233], 0
    v_mul_f32 v184, v176, v162
    v_mul_f32 v185, v176, v163
    v_fma_f32 v184, -v177, v163, v184
    v_fmac_f32 v185, v177, v162
    v_mul_f32 v186, v178, v162
    v_mul_f32 v187, v178, v163
    v_fma_f32 v186, -v179, v163, v186
    v_fmac_f32 v187, v179, v162
    v_mfma_f32_32x32x16_bf16 v[94:109], v[218:221], v[234:237], v[94:109]
    v_mul_f32 v188, v180, v162
    v_mul_f32 v189, v180, v163
    v_fma_f32 v188, -v181, v163, v188
    v_fmac_f32 v189, v181, v162
    v_mul_f32 v190, v182, v162
    v_mul_f32 v191, v182, v163
    v_fma_f32 v190, -v183, v163, v190
    v_fmac_f32 v191, v183, v162
    v_mfma_f32_32x32x16_bf16 v[94:109], v[222:225], v[238:241], v[94:109]
    v_mul_f32 v192, v184, v162
    v_mul_f32 v193, v184, v163
    v_fma_f32 v192, -v185, v163, v192
    v_fmac_f32 v193, v185, v162
    v_mul_f32 v194, v186, v162
    v_mul_f32 v195, v186, v163
    v_fma_f32 v194, -v187, v163, v194
    v_fmac_f32 v195, v187, v162
    v_mfma_f32_32x32x16_bf16 v[94:109], v[226:229], v[242:245], v[94:109]
    v_mul_f32 v196, v188, v162
    v_mul_f32 v197, v188, v163
    v_fma_f32 v196, -v189, v163, v196
    v_fmac_f32 v197, v189, v162
    v_cvt_pk_bf16_f32 v198, v146, v168
    v_cvt_pk_bf16_f32 v206, v147, v169
    v_cvt_pk_bf16_f32 v199, v170, v172
    v_cvt_pk_bf16_f32 v207, v171, v173
    v_cvt_pk_bf16_f32 v200, v174, v176
    v_cvt_pk_bf16_f32 v208, v175, v177
    v_cvt_pk_bf16_f32 v201, v178, v180
    v_cvt_pk_bf16_f32 v209, v179, v181
    v_cvt_pk_bf16_f32 v202, v182, v184
    v_cvt_pk_bf16_f32 v210, v183, v185
    v_cvt_pk_bf16_f32 v203, v186, v188
    v_cvt_pk_bf16_f32 v211, v187, v189
    v_cvt_pk_bf16_f32 v204, v190, v192
    v_cvt_pk_bf16_f32 v212, v191, v193
    v_cvt_pk_bf16_f32 v205, v194, v196
    v_cvt_pk_bf16_f32 v213, v195, v197
    v_cvt_pk_bf16_f32 v214, v44, v45
    v_cvt_pk_bf16_f32 v215, v46, v47
    v_cvt_pk_bf16_f32 v216, v48, v49
    v_cvt_pk_bf16_f32 v217, v50, v51
    v_cvt_pk_bf16_f32 v218, v52, v53
    v_cvt_pk_bf16_f32 v219, v54, v55
    v_cvt_pk_bf16_f32 v220, v56, v57
    v_cvt_pk_bf16_f32 v221, v58, v59
    v_cvt_pk_bf16_f32 v222, v60, v61
    v_cvt_pk_bf16_f32 v223, v62, v63
    v_cvt_pk_bf16_f32 v224, v64, v65
    v_cvt_pk_bf16_f32 v225, v66, v67
    v_cvt_pk_bf16_f32 v226, v68, v69
    v_cvt_pk_bf16_f32 v227, v70, v71
    s_waitcnt vmcnt(0) lgkmcnt(0)
    s_barrier
    s_setprio 2
    v_cvt_pk_bf16_f32 v228, v72, v73
    v_cvt_pk_bf16_f32 v229, v74, v75
    v_mfma_f32_32x32x16_bf16 v[44:59], v[198:201], v[110:113], 0
    v_mfma_f32_32x32x16_bf16 v[60:75], v[206:209], v[110:113], 0
    v_mfma_f32_32x32x16_bf16 v[44:59], v[202:205], v[114:117], v[44:59]
    v_mfma_f32_32x32x16_bf16 v[60:75], v[210:213], v[114:117], v[60:75]
    s_nop 7
    s_nop 2
    v_cvt_pk_bf16_f32 v230, v44, v45
    v_cvt_pk_bf16_f32 v231, v46, v47
    v_cvt_pk_bf16_f32 v232, v48, v49
    v_cvt_pk_bf16_f32 v233, v50, v51
    v_cvt_pk_bf16_f32 v234, v52, v53
    v_cvt_pk_bf16_f32 v235, v54, v55
    v_cvt_pk_bf16_f32 v236, v56, v57
    v_cvt_pk_bf16_f32 v237, v58, v59
    v_cvt_pk_bf16_f32 v238, v60, v61
    v_cvt_pk_bf16_f32 v239, v62, v63
    v_cvt_pk_bf16_f32 v240, v64, v65
    v_cvt_pk_bf16_f32 v241, v66, v67
    v_cvt_pk_bf16_f32 v242, v68, v69
    s_mov_b32 exec_hi, 0
    buffer_load_dword v84, v85, s[8:11], 0 offen sc1
    s_mov_b64 exec, -1
    v_cvt_pk_bf16_f32 v243, v70, v71
    v_cvt_pk_bf16_f32 v244, v72, v73
    v_cvt_pk_bf16_f32 v245, v74, v75
    v_mfma_f32_32x32x16_bf16 v[94:109], v[214:217], v[230:233], v[94:109]
    v_mov_b32 v44, 0
    v_mov_b32 v45, 0
    v_mov_b32 v46, 0
    v_mov_b32 v47, 0
    v_mov_b32 v48, 0
    v_mov_b32 v49, 0
    v_mov_b32 v50, 0
    v_mov_b32 v51, 0
    v_mfma_f32_32x32x16_bf16 v[94:109], v[218:221], v[234:237], v[94:109]
    v_mov_b32 v52, 0
    v_mov_b32 v53, 0
    v_mov_b32 v54, 0
    v_mov_b32 v55, 0
    v_mov_b32 v56, 0
    v_mov_b32 v57, 0
    v_mov_b32 v58, 0
    v_mov_b32 v59, 0
    v_mfma_f32_32x32x16_bf16 v[94:109], v[222:225], v[238:241], v[94:109]
    v_mov_b32 v60, 0
    v_mov_b32 v61, 0
    v_mov_b32 v62, 0
    v_mov_b32 v63, 0
    v_mov_b32 v64, 0
    v_mov_b32 v65, 0
    v_mov_b32 v66, 0
    v_mov_b32 v67, 0
    v_mfma_f32_32x32x16_bf16 v[94:109], v[226:229], v[242:245], v[94:109]
    v_mov_b32 v68, 0
    v_mov_b32 v69, 0
    v_mov_b32 v70, 0
    v_mov_b32 v71, 0
    v_mov_b32 v72, 0
    v_mov_b32 v73, 0
    v_mov_b32 v74, 0
    v_mov_b32 v75, 0
    s_setprio 2
    s_setprio 2
    s_waitcnt vmcnt(0)
L_poll0:
    v_cmp_ne_u32 vcc, v122, v84
    s_nop 4
    s_cmp_eq_u32 vcc_lo, 0
    s_cbranch_scc1 L_poll0_l2
    s_cmp_eq_u32 vcc_hi, 0
    s_cbranch_scc1 L_poll0_ok
    s_sub_u32 s82, s82, 1
    s_cmp_gt_u32 s82, 399994
    s_cselect_b32 exec_hi, 0, -1
    buffer_load_dword v84, v85, s[8:11], 0 offen sc1
    s_waitcnt vmcnt(0)
    s_mov_b64 exec, -1
    s_cmp_lg_u32 s82, 0
    s_cbranch_scc1 L_poll0
    s_branch L_poll0_ok
L_poll0_l2:
    s_add_u32 s38, s38, 131072
L_poll0_ok:
    s_barrier
    s_mov_b64 exec, 0xff
    ds_write_b32 v37, v38 offset:2048
    s_mov_b64 exec, -1
    s_sub_u32 m0, s51, 8320
    s_add_u32 s73, s38, 8192
    buffer_load_dwordx4 v20, s[8:11], s38 offen sc1 lds
    buffer_load_dwordx4 v20, s[8:11], s38 offen offset:1024 sc1 lds
    s_add_u32 m0, s51, 0
    s_nop 0
    buffer_load_dwordx4 v20, s[8:11], s73 offen sc1 lds
    buffer_load_dwordx4 v20, s[8:11], s73 offen offset:1024 sc1 lds
    s_setprio 2
    s_nop 7
    buffer_load_dwordx4 v[86:89], v126, s[64:67], s72 offen
    buffer_load_dwordx4 v[90:93], v126, s[64:67], s72 offen offset:16
    s_and_b32 s76, s3, 3
    s_lshl_b32 s73, s76, 11
    s_add_u32 s73, s73, 131072
    v_add_u32 v6, s73, v4
    s_bfe_u32 s73, s3, 0x10001
    s_mul_i32 s73, s73, 4160
    s_add_u32 s73, s73, 147516
    v_mov_b32 v128, s73
    v_and_b32 v8, 1, v1
    v_cmp_eq_u32 s[78:79], 0, v8
    v_lshl_add_u32 v8, v2, 4, v128
    s_bitcmp1_b32 s3, 0
    s_cbranch_scc1 L_red_odd
    ds_write_b128 v123, v[106:109] offset:3072
    ds_write_b32 v123, v105 offset:2060
    s_branch L_red_done
L_red_odd:
    ds_write_b128 v123, v[94:97]
    ds_write_b128 v123, v[98:101] offset:1024
    ds_write_b96 v123, v[102:104] offset:2048
L_red_done:
    ds_write_b32 v127, v127
    v_xor_b32 v127, 4, v127
    s_mov_b32 s75, 400000
L_kfl:
    ds_read_b32 v7, v127
    s_waitcnt lgkmcnt(0)
    v_cmp_ne_u32 vcc, v7, v127
    s_nop 4
    s_cbranch_vccz L_kfl_ok
    s_sub_u32 s75, s75, 1
    s_cmp_lg_u32 s75, 0
    s_cbranch_scc1 L_kfl
L_kfl_ok:
    s_bitcmp1_b32 s3, 0
    s_cbranch_scc1 L_exp_odd
    ds_read_b128 v[214:217], v123 offset:0
    ds_read_b128 v[218:221], v123 offset:1024
    ds_read_b128 v[222:225], v123 offset:2048
    ds_write_b32 v128, v19
    v_lshl_add_u32 v8, v3, 9, v8
    s_waitcnt lgkmcnt(1)
    v_add_f32 v94, v94, v214
    v_add_f32 v95, v95, v215
    v_add_f32 v96, v96, v216
    v_add_f32 v97, v97, v217
    v_add_f32 v98, v98, v218
    v_add_f32 v99, v99, v219
    v_add_f32 v100, v100, v220
    v_add_f32 v101, v101, v221
    v_add_f32 v102, v102, v222
    v_add_f32 v103, v103, v223
    v_add_f32 v104, v104, v224
    s_bitcmp1_b32 s3, 1
    s_cselect_b32 s76, 0, 16
    s_lshl_b32 s76, s81, s76
    s_and_b32 s76, s76, 0xffff0000
    s_mov_b64 exec, 1
    v_add_f32 v94, s76, v94
    s_mov_b64 exec, -1
    v_cvt_pk_bf16_f32 v230, v94, v95
    v_cvt_pk_bf16_f32 v231, v96, v97
    v_cvt_pk_bf16_f32 v232, v98, v99
    v_cvt_pk_bf16_f32 v233, v100, v101
    v_cvt_pk_bf16_f32 v234, v102, v102
    v_cvt_pk_bf16_f32 v235, v102, v103
    v_cvt_pk_bf16_f32 v236, v103, v103
    v_cvt_pk_bf16_f32 v237, v104, v104
    ds_write_b128 v8, v[230:233] offset:4
    ds_write_b128 v8, v[234:237] offset:1028
    s_branch L_exp_done
L_exp_odd:
    ds_read_b128 v[226:229], v123 offset:3072
    ds_read_b32 v225, v123 offset:2060
    v_lshl_add_u32 v8, v3, 10, v8
    s_waitcnt lgkmcnt(0)
    v_add_f32 v105, v105, v225
    v_add_f32 v106, v106, v226
    v_add_f32 v107, v107, v227
    v_add_f32 v108, v108, v228
    v_cndmask_b32 v109, v106, v105, s[78:79]
    v_cvt_pk_bf16_f32 v238, v105, v105
    v_cvt_pk_bf16_f32 v239, v105, v105
    v_cvt_pk_bf16_f32 v240, v109, v106
    v_cvt_pk_bf16_f32 v241, v106, v106
    v_cndmask_b32 v109, v108, v107, s[78:79]
    v_cvt_pk_bf16_f32 v242, v107, v107
    v_cvt_pk_bf16_f32 v243, v107, v107
    v_cvt_pk_bf16_f32 v244, v109, v108
    v_cvt_pk_bf16_f32 v245, v108, v108
    ds_write_b128 v8, v[238:241] offset:2052
    ds_write_b128 v8, v[242:245] offset:2564
L_exp_done:
    s_waitcnt vmcnt(2) lgkmcnt(0)
    s_barrier
    s_setprio 3
    ds_read_b128 v[76:79], v6
    ds_read_b128 v[80:83], v6 offset:1024
    s_waitcnt lgkmcnt(0)
    s_setprio 0
L_b2:
    s_add_u32 s50, s50, 16384
    s_and_b32 s50, s50, 0x1ffff
    ds_read_b128 v[126:129], v23 offset:0
    ds_read_b128 v[130:133], v24 offset:0
    ds_read_b128 v[134:137], v25 offset:0
    s_waitcnt lgkmcnt(2)
    v_mfma_f32_32x32x16_bf16 v[94:109], v[126:129], v[76:79], 0
    s_mov_b32 exec_lo, 0
    s_mov_b32 exec_hi, 0xff
    ds_write_b32 v37, v38 offset:2048
    s_mov_b64 exec, -1
    ds_write_b128 v39, v[56:59]
    s_and_b32 s72, s3, 3
    s_cbranch_scc1 L_nohead
    ds_write_b64 v40, v[56:57]
L_nohead:
    s_nop 2
    s_waitcnt lgkmcnt(0)
    s_setprio 3
    v_exp_f32 v94, v94
    v_exp_f32 v95, v95
    ds_read_b128 v[138:141], v23 offset:2080
    s_cmp_ge_u32 s3, 4
    s_cbranch_scc1 L_noc1
    s_waitcnt vmcnt(0)
    s_mov_b32 s82, 400000
L_poll1b:
    v_cmp_ne_u32 vcc, s7, v84
    s_nop 4
    s_cbranch_vccz L_poll1b_ok
    buffer_load_dword v84, v21, s[8:11], 0 offen sc1
    s_waitcnt vmcnt(0)
    s_sub_u32 s82, s82, 1
    s_cmp_lg_u32 s82, 0
    s_cbranch_scc1 L_poll1b
L_poll1b_ok:
    s_add_u32 s77, s50, 8192
    s_add_u32 m0, s51, 16640
    s_nop 0
    buffer_load_dwordx4 v20, s[8:11], s50 offen sc1 lds
    buffer_load_dwordx4 v20, s[8:11], s50 offen offset:1024 sc1 lds
    s_add_u32 m0, s51, 24960
    s_nop 0
    buffer_load_dwordx4 v20, s[8:11], s77 offen sc1 lds
    buffer_load_dwordx4 v20, s[8:11], s77 offen offset:1024 sc1 lds
L_noc1:
    s_add_u32 s50, s50, 16384
    s_and_b32 s50, s50, 0x1ffff
    v_exp_f32 v96, v96
    v_exp_f32 v97, v97
    v_exp_f32 v98, v98
    v_mfma_f32_32x32x16_bf16 v[110:125], v[126:129], v[80:83], 0
    ds_read_b128 v[146:149], v25 offset:2080
    v_exp_f32 v99, v99
    v_exp_f32 v100, v100
    v_exp_f32 v101, v101
    v_exp_f32 v102, v102
    v_exp_f32 v103, v103
    v_exp_f32 v104, v104
    v_smfmac_f32_32x32x32_bf16 v[44:59], v[130:133], v[94:101], v22
    ds_read_b128 v[142:145], v24 offset:2080
    s_mov_b64 exec, 1
    buffer_store_dword v18, v19, s[8:11], s26 offen sc1
    s_mov_b64 exec, -1
    v_exp_f32 v105, v105
    v_exp_f32 v106, v106
    v_exp_f32 v107, v107
    v_exp_f32 v108, v108
    v_exp_f32 v109, v109
    s_setprio 2
    v_exp_f32 v110, v110
    v_exp_f32 v111, v111
    v_smfmac_f32_32x32x32_bf16 v[44:59], v[134:137], v[102:109], v22
    v_exp_f32 v112, v112
    v_exp_f32 v113, v113
    v_exp_f32 v114, v114
    s_waitcnt lgkmcnt(0)
    v_mfma_f32_32x32x16_bf16 v[94:109], v[138:141], v[76:79], 0
    v_exp_f32 v115, v115
    v_exp_f32 v116, v116
    v_exp_f32 v117, v117
    v_exp_f32 v118, v118
    v_exp_f32 v119, v119
    v_exp_f32 v120, v120
    v_smfmac_f32_32x32x32_bf16 v[60:75], v[130:133], v[110:117], v22
    v_exp_f32 v121, v121
    v_exp_f32 v122, v122
    v_exp_f32 v123, v123
    v_exp_f32 v124, v124
    v_exp_f32 v125, v125
    v_exp_f32 v94, v94
    v_exp_f32 v95, v95
    v_smfmac_f32_32x32x32_bf16 v[60:75], v[134:137], v[118:125], v22
    ds_read_b128 v[126:129], v23 offset:4160
    s_cmp_lt_u32 s3, 4
    s_cbranch_scc1 L_nostr
    s_lshl_b32 s74, s5, 2
    s_add_u32 s74, s74, s3
    s_sub_u32 s74, s74, 4
    s_lshl_b32 s74, s74, 16
    s_lshl_b32 s73, s4, 8
    s_add_u32 s74, s74, s73
    s_add_u32 s74, s74, 4194304
    s_add_u32 s75, s74, 32768
    s_waitcnt vmcnt(1)
    v_permlane32_swap_b32 v86, v88
    v_permlane32_swap_b32 v87, v89
    v_permlane32_swap_b32 v90, v92
    v_permlane32_swap_b32 v91, v93
    v_permlane16_swap_b32 v86, v87
    v_permlane16_swap_b32 v88, v89
    v_permlane16_swap_b32 v90, v91
    v_permlane16_swap_b32 v92, v93
    buffer_store_dwordx4 v[86:89], v33, s[8:11], s74 offen sc1
    buffer_store_dwordx4 v[90:93], v33, s[8:11], s75 offen sc1
L_nostr:
    v_exp_f32 v96, v96
    v_exp_f32 v97, v97
    v_exp_f32 v98, v98
    v_mfma_f32_32x32x16_bf16 v[110:125], v[138:141], v[80:83], 0
    ds_read_b128 v[134:137], v25 offset:4160
    v_exp_f32 v99, v99
    v_exp_f32 v100, v100
    v_exp_f32 v101, v101
    v_exp_f32 v102, v102
    v_exp_f32 v103, v103
    v_exp_f32 v104, v104
    v_smfmac_f32_32x32x32_bf16 v[44:59], v[142:145], v[94:101], v22
    ds_read_b128 v[130:133], v24 offset:4160
    v_exp_f32 v105, v105
    v_exp_f32 v106, v106
    v_exp_f32 v107, v107
    v_exp_f32 v108, v108
    v_exp_f32 v109, v109
    s_setprio 1
    v_exp_f32 v110, v110
    v_exp_f32 v111, v111
    v_smfmac_f32_32x32x32_bf16 v[44:59], v[146:149], v[102:109], v22
    v_exp_f32 v112, v112
    v_exp_f32 v113, v113
    v_exp_f32 v114, v114
    s_waitcnt lgkmcnt(0)
    v_mfma_f32_32x32x16_bf16 v[94:109], v[126:129], v[76:79], 0
    v_exp_f32 v115, v115
    v_exp_f32 v116, v116
    v_exp_f32 v117, v117
    v_exp_f32 v118, v118
    v_exp_f32 v119, v119
    v_exp_f32 v120, v120
    v_smfmac_f32_32x32x32_bf16 v[60:75], v[142:145], v[110:117], v22
    v_exp_f32 v121, v121
    v_exp_f32 v122, v122
    v_exp_f32 v123, v123
    v_exp_f32 v124, v124
    v_exp_f32 v125, v125
    v_exp_f32 v94, v94
    v_exp_f32 v95, v95
    v_smfmac_f32_32x32x32_bf16 v[60:75], v[146:149], v[118:125], v22
    ds_read_b128 v[138:141], v23 offset:6240
    v_exp_f32 v96, v96
    v_exp_f32 v97, v97
    v_exp_f32 v98, v98
    v_mfma_f32_32x32x16_bf16 v[110:125], v[126:129], v[80:83], 0
    ds_read_b128 v[146:149], v25 offset:6240
    v_exp_f32 v99, v99
    v_exp_f32 v100, v100
    v_exp_f32 v101, v101
    v_exp_f32 v102, v102
    v_exp_f32 v103, v103
    v_exp_f32 v104, v104
    v_smfmac_f32_32x32x32_bf16 v[44:59], v[130:133], v[94:101], v22
    ds_read_b128 v[142:145], v24 offset:6240
    v_exp_f32 v105, v105
    v_exp_f32 v106, v106
    v_exp_f32 v107, v107
    v_exp_f32 v108, v108
    v_exp_f32 v109, v109
    s_setprio 0
    v_exp_f32 v110, v110
    v_exp_f32 v111, v111
    v_smfmac_f32_32x32x32_bf16 v[44:59], v[134:137], v[102:109], v22
    s_cmp_lt_u32 s3, 4
    s_cbranch_scc1 L_nof3
    s_waitcnt vmcnt(0)
    s_mov_b64 exec, 1
    buffer_store_dword v11, v19, s[8:11], s30 offen sc1
    s_mov_b64 exec, -1
L_nof3:
    v_exp_f32 v112, v112
    v_exp_f32 v113, v113
    v_exp_f32 v114, v114
    s_waitcnt lgkmcnt(0)
    v_mfma_f32_32x32x16_bf16 v[94:109], v[138:141], v[76:79], 0
    v_exp_f32 v115, v115
    v_exp_f32 v116, v116
    v_exp_f32 v117, v117
    v_exp_f32 v118, v118
    v_exp_f32 v119, v119
    v_exp_f32 v120, v120
    v_smfmac_f32_32x32x32_bf16 v[60:75], v[130:133], v[110:117], v22
    v_exp_f32 v121, v121
    v_exp_f32 v122, v122
    v_exp_f32 v123, v123
    v_exp_f32 v124, v124
    v_exp_f32 v125, v125
    s_waitcnt vmcnt(1)
    s_barrier
    s_setprio 3
    v_exp_f32 v94, v94
    v_exp_f32 v95, v95
    v_smfmac_f32_32x32x32_bf16 v[60:75], v[134:137], v[118:125], v22
    ds_read_b128 v[126:129], v23 offset:16640
    v_exp_f32 v96, v96
    v_exp_f32 v97, v97
    v_exp_f32 v98, v98
    v_mfma_f32_32x32x16_bf16 v[110:125], v[138:141], v[80:83], 0
    ds_read_b128 v[134:137], v25 offset:16640
    s_mov_b32 m0, s51
    s_nop 0
    buffer_load_dwordx4 v20, s[8:11], s50 offen sc1 lds
    v_exp_f32 v99, v99
    v_exp_f32 v100, v100
    v_exp_f32 v101, v101
    v_exp_f32 v102, v102
    v_exp_f32 v103, v103
    v_exp_f32 v104, v104
    v_smfmac_f32_32x32x32_bf16 v[44:59], v[142:145], v[94:101], v22
    ds_read_b128 v[130:133], v24 offset:16640
    buffer_load_dwordx4 v20, s[8:11], s50 offen offset:1024 sc1 lds
    s_add_u32 s50, s50, 16384
    s_and_b32 s50, s50, 0x1ffff
    ds_read_b32 v238, v35
    ds_read_b128 v[230:233], v35 offset:4
    v_exp_f32 v105, v105
    v_exp_f32 v106, v106
    v_exp_f32 v107, v107
    v_exp_f32 v108, v108
    v_exp_f32 v109, v109
    v_exp_f32 v110, v110
    v_exp_f32 v111, v111
    v_smfmac_f32_32x32x32_bf16 v[44:59], v[146:149], v[102:109], v22
    v_exp_f32 v112, v112
    v_exp_f32 v113, v113
    v_exp_f32 v114, v114
    s_waitcnt lgkmcnt(0)
    v_mfma_f32_32x32x16_bf16 v[94:109], v[126:129], v[76:79], 0
    v_exp_f32 v115, v115
    v_alignbit_b32 v234, v230, v238, 16
    v_exp_f32 v116, v116
    v_alignbit_b32 v235, v231, v230, 16
    v_exp_f32 v117, v117
    v_alignbit_b32 v236, v232, v231, 16
    v_exp_f32 v118, v118
    v_alignbit_b32 v237, v233, v232, 16
    v_exp_f32 v119, v119
    v_add_u32 v8, 4160, v36
    v_exp_f32 v120, v120
    v_smfmac_f32_32x32x32_bf16 v[60:75], v[142:145], v[110:117], v22
    v_exp_f32 v121, v121
    v_exp_f32 v122, v122
    v_exp_f32 v123, v123
    v_exp_f32 v124, v124
    v_exp_f32 v125, v125
    v_exp_f32 v94, v94
    v_exp_f32 v95, v95
    v_smfmac_f32_32x32x32_bf16 v[60:75], v[146:149], v[118:125], v22
    ds_read_b128 v[138:141], v23 offset:18720
    v_exp_f32 v96, v96
    v_exp_f32 v97, v97
    v_exp_f32 v98, v98
    v_mfma_f32_32x32x16_bf16 v[110:125], v[126:129], v[80:83], 0
    ds_read_b128 v[146:149], v25 offset:18720
    v_exp_f32 v99, v99
    v_exp_f32 v100, v100
    v_exp_f32 v101, v101
    v_exp_f32 v102, v102
    v_exp_f32 v103, v103
    v_exp_f32 v104, v104
    v_smfmac_f32_32x32x32_bf16 v[44:59], v[130:133], v[94:101], v22
    ds_read_b128 v[142:145], v24 offset:18720
    buffer_load_dword v84, v28, s[8:11], s21 offen sc1
    v_exp_f32 v105, v105
    v_exp_f32 v106, v106
    v_exp_f32 v107, v107
    v_exp_f32 v108, v108
    v_exp_f32 v109, v109
    s_setprio 2
    v_exp_f32 v110, v110
    v_exp_f32 v111, v111
    v_smfmac_f32_32x32x32_bf16 v[44:59], v[134:137], v[102:109], v22
    v_exp_f32 v112, v112
    v_exp_f32 v113, v113
    v_exp_f32 v114, v114
    s_waitcnt lgkmcnt(0)
    v_mfma_f32_32x32x16_bf16 v[94:109], v[138:141], v[76:79], 0
    ds_write_b128 v36, v[230:233] offset:12484
    v_exp_f32 v115, v115
    v_exp_f32 v116, v116
    v_exp_f32 v117, v117
    v_exp_f32 v118, v118
    v_exp_f32 v119, v119
    v_exp_f32 v120, v120
    v_smfmac_f32_32x32x32_bf16 v[60:75], v[130:133], v[110:117], v22
    ds_write_b128 v36, v[234:237] offset:8324
    v_exp_f32 v121, v121
    v_exp_f32 v122, v122
    v_exp_f32 v123, v123
    ds_write2_b32 v8, v230, v231 offset0:2 offset1:3
    v_exp_f32 v124, v124
    v_exp_f32 v125, v125
    v_exp_f32 v94, v94
    v_exp_f32 v95, v95
    v_smfmac_f32_32x32x32_bf16 v[60:75], v[134:137], v[118:125], v22
    ds_read_b128 v[126:129], v23 offset:20800
    v_exp_f32 v96, v96
    v_exp_f32 v97, v97
    v_exp_f32 v98, v98
    v_mfma_f32_32x32x16_bf16 v[110:125], v[138:141], v[80:83], 0
    ds_read_b128 v[134:137], v25 offset:20800
    v_exp_f32 v99, v99
    v_exp_f32 v100, v100
    v_exp_f32 v101, v101
    v_exp_f32 v102, v102
    v_exp_f32 v103, v103
    v_exp_f32 v104, v104
    v_smfmac_f32_32x32x32_bf16 v[44:59], v[142:145], v[94:101], v22
    ds_read_b128 v[130:133], v24 offset:20800
    v_exp_f32 v105, v105
    v_exp_f32 v106, v106
    v_exp_f32 v107, v107
    v_exp_f32 v108, v108
    v_exp_f32 v109, v109
    s_setprio 1
    v_exp_f32 v110, v110
    v_exp_f32 v111, v111
    v_smfmac_f32_32x32x32_bf16 v[44:59], v[146:149], v[102:109], v22
    s_waitcnt vmcnt(0)
    s_mov_b32 s82, 400000
L_poll3:
    v_cmp_ne_u32 vcc, s7, v84
    s_nop 4
    s_cbranch_vccz L_poll3_ok
    buffer_load_dword v84, v28, s[8:11], s21 offen sc1
    s_waitcnt vmcnt(0)
    s_sub_u32 s82, s82, 1
    s_cmp_lg_u32 s82, 0
    s_cbranch_scc1 L_poll3
L_poll3_ok:
    buffer_load_dwordx4 v[86:89], v32, s[8:11], s22 offen sc1
    v_exp_f32 v112, v112
    v_exp_f32 v113, v113
    v_exp_f32 v114, v114
    s_waitcnt lgkmcnt(0)
    v_mfma_f32_32x32x16_bf16 v[94:109], v[126:129], v[76:79], 0
    ds_write2_b32 v8, v232, v233 offset0:4 offset1:5
    v_exp_f32 v115, v115
    v_exp_f32 v116, v116
    v_exp_f32 v117, v117
    v_exp_f32 v118, v118
    v_exp_f32 v119, v119
    v_exp_f32 v120, v120
    v_smfmac_f32_32x32x32_bf16 v[60:75], v[142:145], v[110:117], v22
    ds_write2_b32 v36, v234, v235 offset0:2 offset1:3
    v_exp_f32 v121, v121
    v_exp_f32 v122, v122
    v_exp_f32 v123, v123
    ds_write2_b32 v36, v236, v237 offset0:4 offset1:5
    v_exp_f32 v124, v124
    v_exp_f32 v125, v125
    v_exp_f32 v94, v94
    v_exp_f32 v95, v95
    v_smfmac_f32_32x32x32_bf16 v[60:75], v[146:149], v[118:125], v22
    ds_read_b128 v[138:141], v23 offset:22880
    v_exp_f32 v96, v96
    v_exp_f32 v97, v97
    v_exp_f32 v98, v98
    v_mfma_f32_32x32x16_bf16 v[110:125], v[126:129], v[80:83], 0
    ds_read_b128 v[146:149], v25 offset:22880
    v_exp_f32 v99, v99
    v_exp_f32 v100, v100
    v_exp_f32 v101, v101
    v_exp_f32 v102, v102
    v_exp_f32 v103, v103
    v_exp_f32 v104, v104
    v_smfmac_f32_32x32x32_bf16 v[44:59], v[130:133], v[94:101], v22
    ds_read_b128 v[142:145], v24 offset:22880
    v_exp_f32 v105, v105
    v_exp_f32 v106, v106
    v_exp_f32 v107, v107
    v_exp_f32 v108, v108
    v_exp_f32 v109, v109
    s_setprio 0
    v_exp_f32 v110, v110
    v_exp_f32 v111, v111
    v_smfmac_f32_32x32x32_bf16 v[44:59], v[134:137], v[102:109], v22
    v_exp_f32 v112, v112
    v_exp_f32 v113, v113
    v_exp_f32 v114, v114
    s_waitcnt lgkmcnt(0)
    v_mfma_f32_32x32x16_bf16 v[94:109], v[138:141], v[76:79], 0
    v_exp_f32 v115, v115
    s_waitcnt vmcnt(0)
    v_perm_b32 v90, v88, v89, s24
    v_exp_f32 v116, v116
    v_perm_b32 v91, v86, v87, s24
    v_exp_f32 v117, v117
    v_perm_b32 v92, v88, v89, s25
    v_exp_f32 v118, v118
    v_perm_b32 v93, v86, v87, s25
    v_exp_f32 v119, v119
    v_exp_f32 v120, v120
    v_smfmac_f32_32x32x32_bf16 v[60:75], v[130:133], v[110:117], v22
    ds_write_b64 v31, v[90:91]
    ds_write_b64 v31, v[92:93] offset:7600
    v_exp_f32 v121, v121
    v_exp_f32 v122, v122
    v_exp_f32 v123, v123
    v_exp_f32 v124, v124
    v_exp_f32 v125, v125
    s_waitcnt lgkmcnt(0)
    s_waitcnt vmcnt(2)
    s_barrier
    s_setprio 3
    v_exp_f32 v94, v94
    v_exp_f32 v95, v95
    v_smfmac_f32_32x32x32_bf16 v[60:75], v[134:137], v[118:125], v22
    ds_read_b128 v[126:129], v23 offset:0
    ds_read_b64 v[182:183], v26 offset:0
    ds_read_b64 v[184:185], v26 offset:8
    ds_read_b128 v[190:193], v27 offset:2560
    ds_read_b128 v[194:197], v27 offset:0
    v_exp_f32 v96, v96
    v_exp_f32 v97, v97
    v_exp_f32 v98, v98
    v_mfma_f32_32x32x16_bf16 v[110:125], v[138:141], v[80:83], 0
    ds_read_b128 v[134:137], v25 offset:0
    s_add_u32 m0, s51, 16640
    s_nop 0
    buffer_load_dwordx4 v20, s[8:11], s50 offen sc1 lds
    ds_read_b64 v[186:187], v26 offset:2048
    ds_read_b64 v[188:189], v26 offset:2056
    ds_read_b64 v[198:199], v26 offset:32
    ds_read_b64 v[200:201], v26 offset:40
    v_exp_f32 v99, v99
    v_exp_f32 v100, v100
    v_exp_f32 v101, v101
    v_exp_f32 v102, v102
    v_exp_f32 v103, v103
    v_exp_f32 v104, v104
    v_smfmac_f32_32x32x32_bf16 v[44:59], v[142:145], v[94:101], v22
    ds_read_b128 v[130:133], v24 offset:0
    buffer_load_dwordx4 v20, s[8:11], s50 offen offset:1024 sc1 lds
    s_add_u32 s50, s50, 16384
    s_and_b32 s50, s50, 0x1ffff
    ds_read_b128 v[206:209], v27 offset:2592
    ds_read_b128 v[210:213], v27 offset:32
    ds_read_b64 v[202:203], v26 offset:2080
    ds_read_b64 v[204:205], v26 offset:2088
    v_exp_f32 v105, v105
    v_exp_f32 v106, v106
    v_exp_f32 v107, v107
    v_exp_f32 v108, v108
    v_exp_f32 v109, v109
    v_exp_f32 v110, v110
    v_exp_f32 v111, v111
    v_smfmac_f32_32x32x32_bf16 v[44:59], v[146:149], v[102:109], v22
    v_exp_f32 v112, v112
    v_exp_f32 v113, v113
    v_exp_f32 v114, v114
    s_waitcnt lgkmcnt(0)
    v_mfma_f32_32x32x16_bf16 v[94:109], v[126:129], v[76:79], 0
    v_exp_f32 v115, v115
    v_exp_f32 v116, v116
    v_exp_f32 v117, v117
    v_mfma_f32_32x32x16_bf16 v[166:181], v[182:185], v[194:197], 0
    v_exp_f32 v118, v118
    v_exp_f32 v119, v119
    v_exp_f32 v120, v120
    v_smfmac_f32_32x32x32_bf16 v[60:75], v[142:145], v[110:117], v22
    ds_read_b64 v[214:215], v26 offset:64
    ds_read_b64 v[216:217], v26 offset:72
    v_exp_f32 v121, v121
    v_exp_f32 v122, v122
    v_exp_f32 v123, v123
    v_mfma_f32_32x32x16_bf16 v[150:165], v[182:185], v[190:193], 0
    v_exp_f32 v124, v124
    v_exp_f32 v125, v125
    v_exp_f32 v94, v94
    v_exp_f32 v95, v95
    v_smfmac_f32_32x32x32_bf16 v[60:75], v[146:149], v[118:125], v22
    ds_read_b128 v[138:141], v23 offset:2080
    ds_read_b128 v[222:225], v27 offset:2640
    ds_read_b128 v[226:229], v27 offset:80
    v_exp_f32 v96, v96
    v_exp_f32 v97, v97
    v_exp_f32 v98, v98
    v_mfma_f32_32x32x16_bf16 v[110:125], v[126:129], v[80:83], 0
    ds_read_b128 v[146:149], v25 offset:2080
    v_exp_f32 v99, v99
    v_exp_f32 v100, v100
    v_exp_f32 v101, v101
    v_mfma_f32_32x32x16_bf16 v[166:181], v[186:189], v[190:193], v[166:181]
    ds_read_b64 v[218:219], v26 offset:2112
    ds_read_b64 v[220:221], v26 offset:2120
    v_exp_f32 v102, v102
    v_exp_f32 v103, v103
    v_exp_f32 v104, v104
    v_smfmac_f32_32x32x32_bf16 v[44:59], v[130:133], v[94:101], v22
    ds_read_b128 v[142:145], v24 offset:2080
    v_exp_f32 v105, v105
    v_exp_f32 v106, v106
    v_exp_f32 v107, v107
    v_mfma_f32_32x32x16_bf16 v[166:181], v[198:201], v[210:213], v[166:181]
    v_exp_f32 v108, v108
    v_exp_f32 v109, v109
    s_setprio 2
    v_exp_f32 v110, v110
    v_exp_f32 v111, v111
    v_smfmac_f32_32x32x32_bf16 v[44:59], v[134:137], v[102:109], v22
    v_exp_f32 v112, v112
    v_exp_f32 v113, v113
    v_exp_f32 v114, v114
    s_waitcnt lgkmcnt(0)
    v_mfma_f32_32x32x16_bf16 v[94:109], v[138:141], v[76:79], 0
    v_exp_f32 v115, v115
    v_exp_f32 v116, v116
    v_exp_f32 v117, v117
    v_mfma_f32_32x32x16_bf16 v[150:165], v[198:201], v[206:209], v[150:165]
    v_exp_f32 v118, v118
    v_exp_f32 v119, v119
    v_exp_f32 v120, v120
    v_smfmac_f32_32x32x32_bf16 v[60:75], v[130:133], v[110:117], v22
    ds_read_b64 v[230:231], v26 offset:96
    ds_read_b64 v[232:233], v26 offset:104
    v_exp_f32 v121, v121
    v_exp_f32 v122, v122
    v_exp_f32 v123, v123
    v_mfma_f32_32x32x16_bf16 v[166:181], v[202:205], v[206:209], v[166:181]
    v_exp_f32 v124, v124
    v_exp_f32 v125, v125
    v_exp_f32 v94, v94
    v_exp_f32 v95, v95
    v_smfmac_f32_32x32x32_bf16 v[60:75], v[134:137], v[118:125], v22
    ds_read_b128 v[126:129], v23 offset:4160
    ds_read_b128 v[238:241], v27 offset:2672
    ds_read_b128 v[242:245], v27 offset:112
    v_exp_f32 v96, v96
    v_exp_f32 v97, v97
    v_exp_f32 v98, v98
    v_mfma_f32_32x32x16_bf16 v[110:125], v[138:141], v[80:83], 0
    ds_read_b128 v[134:137], v25 offset:4160
    v_exp_f32 v99, v99
    v_exp_f32 v100, v100
    v_exp_f32 v101, v101
    v_mfma_f32_32x32x16_bf16 v[166:181], v[214:217], v[226:229], v[166:181]
    ds_read_b64 v[234:235], v26 offset:2144
    ds_read_b64 v[236:237], v26 offset:2152
    v_exp_f32 v102, v102
    v_exp_f32 v103, v103
    v_exp_f32 v104, v104
    v_smfmac_f32_32x32x32_bf16 v[44:59], v[142:145], v[94:101], v22
    ds_read_b128 v[130:133], v24 offset:4160
    v_exp_f32 v105, v105
    v_exp_f32 v106, v106
    v_exp_f32 v107, v107
    v_mfma_f32_32x32x16_bf16 v[150:165], v[214:217], v[222:225], v[150:165]
    v_exp_f32 v108, v108
    v_exp_f32 v109, v109
    s_setprio 1
    v_exp_f32 v110, v110
    v_exp_f32 v111, v111
    v_smfmac_f32_32x32x32_bf16 v[44:59], v[146:149], v[102:109], v22
    v_exp_f32 v112, v112
    v_exp_f32 v113, v113
    v_exp_f32 v114, v114
    s_waitcnt lgkmcnt(0)
    v_mfma_f32_32x32x16_bf16 v[94:109], v[126:129], v[76:79], 0
    v_exp_f32 v115, v115
    v_exp_f32 v116, v116
    v_exp_f32 v117, v117
    v_mfma_f32_32x32x16_bf16 v[166:181], v[218:221], v[222:225], v[166:181]
    v_exp_f32 v118, v118
    v_exp_f32 v119, v119
    v_exp_f32 v120, v120
    v_smfmac_f32_32x32x32_bf16 v[60:75], v[142:145], v[110:117], v22
    ds_read_b64 v[182:183], v26 offset:128
    ds_read_b64 v[184:185], v26 offset:136
    v_exp_f32 v121, v121
    v_exp_f32 v122, v122
    v_exp_f32 v123, v123
    v_mfma_f32_32x32x16_bf16 v[166:181], v[230:233], v[242:245], v[166:181]
    ds_read_b128 v[190:193], v27 offset:2720
    ds_read_b128 v[194:197], v27 offset:160
    v_exp_f32 v124, v124
    v_exp_f32 v125, v125
    v_exp_f32 v94, v94
    v_exp_f32 v95, v95
    v_smfmac_f32_32x32x32_bf16 v[60:75], v[146:149], v[118:125], v22
    ds_read_b128 v[138:141], v23 offset:6240
    ds_read_b64 v[186:187], v26 offset:2176
    ds_read_b64 v[188:189], v26 offset:2184
    v_exp_f32 v96, v96
    v_exp_f32 v97, v97
    v_exp_f32 v98, v98
    v_mfma_f32_32x32x16_bf16 v[110:125], v[126:129], v[80:83], 0
    ds_read_b128 v[146:149], v25 offset:6240
    ds_read_b64 v[198:199], v26 offset:160
    ds_read_b64 v[200:201], v26 offset:168
    v_exp_f32 v99, v99
    v_exp_f32 v100, v100
    v_exp_f32 v101, v101
    v_mfma_f32_32x32x16_bf16 v[150:165], v[230:233], v[238:241], v[150:165]
    ds_read_b128 v[206:209], v27 offset:2752
    ds_read_b128 v[210:213], v27 offset:192
    v_exp_f32 v102, v102
    v_exp_f32 v103, v103
    v_exp_f32 v104, v104
    v_smfmac_f32_32x32x32_bf16 v[44:59], v[130:133], v[94:101], v22
    ds_read_b128 v[142:145], v24 offset:6240
    ds_read_b64 v[202:203], v26 offset:2208
    ds_read_b64 v[204:205], v26 offset:2216
    v_exp_f32 v105, v105
    v_exp_f32 v106, v106
    v_exp_f32 v107, v107
    v_mfma_f32_32x32x16_bf16 v[166:181], v[234:237], v[238:241], v[166:181]
    v_exp_f32 v108, v108
    v_exp_f32 v109, v109
    s_setprio 0
    v_exp_f32 v110, v110
    v_exp_f32 v111, v111
    v_smfmac_f32_32x32x32_bf16 v[44:59], v[134:137], v[102:109], v22
    v_exp_f32 v112, v112
    v_exp_f32 v113, v113
    v_exp_f32 v114, v114
    s_waitcnt lgkmcnt(0)
    v_mfma_f32_32x32x16_bf16 v[94:109], v[138:141], v[76:79], 0
    v_exp_f32 v115, v115
    v_exp_f32 v116, v116
    v_exp_f32 v117, v117
    v_mfma_f32_32x32x16_bf16 v[166:181], v[182:185], v[194:197], v[166:181]
    v_exp_f32 v118, v118
    v_exp_f32 v119, v119
    v_exp_f32 v120, v120
    v_smfmac_f32_32x32x32_bf16 v[60:75], v[130:133], v[110:117], v22
    buffer_load_dword v84, v43, s[8:11], s27 offen sc1
    ds_read_b64 v[214:215], v26 offset:192
    ds_read_b64 v[216:217], v26 offset:200
    v_exp_f32 v121, v121
    v_exp_f32 v122, v122
    v_exp_f32 v123, v123
    v_mfma_f32_32x32x16_bf16 v[150:165], v[182:185], v[190:193], v[150:165]
    v_exp_f32 v124, v124
    v_exp_f32 v125, v125
    s_waitcnt vmcnt(1)
    s_barrier
    s_setprio 3
    v_exp_f32 v94, v94
    v_exp_f32 v95, v95
    v_smfmac_f32_32x32x32_bf16 v[60:75], v[134:137], v[118:125], v22
    ds_read_b128 v[126:129], v23 offset:16640
    ds_read_b128 v[222:225], v27 offset:2800
    ds_read_b128 v[226:229], v27 offset:240
    v_exp_f32 v96, v96
    v_exp_f32 v97, v97
    v_exp_f32 v98, v98
    v_mfma_f32_32x32x16_bf16 v[110:125], v[138:141], v[80:83], 0
    ds_read_b128 v[134:137], v25 offset:16640
    s_mov_b32 m0, s51
    s_nop 0
    buffer_load_dwordx4 v20, s[8:11], s50 offen sc1 lds
    v_exp_f32 v99, v99
    v_exp_f32 v100, v100
    v_exp_f32 v101, v101
    v_mfma_f32_32x32x16_bf16 v[166:181], v[186:189], v[190:193], v[166:181]
    ds_read_b64 v[218:219], v26 offset:2240
    ds_read_b64 v[220:221], v26 offset:2248
    v_exp_f32 v102, v102
    v_exp_f32 v103, v103
    v_exp_f32 v104, v104
    v_smfmac_f32_32x32x32_bf16 v[44:59], v[142:145], v[94:101], v22
    ds_read_b128 v[130:133], v24 offset:16640
    buffer_load_dwordx4 v20, s[8:11], s50 offen offset:1024 sc1 lds
    s_add_u32 s50, s50, 16384
    s_and_b32 s50, s50, 0x1ffff
    v_exp_f32 v105, v105
    v_exp_f32 v106, v106
    v_exp_f32 v107, v107
    v_mfma_f32_32x32x16_bf16 v[166:181], v[198:201], v[210:213], v[166:181]
    v_exp_f32 v108, v108
    v_exp_f32 v109, v109
    v_exp_f32 v110, v110
    v_exp_f32 v111, v111
    v_smfmac_f32_32x32x32_bf16 v[44:59], v[146:149], v[102:109], v22
    v_exp_f32 v112, v112
    v_exp_f32 v113, v113
    v_exp_f32 v114, v114
    s_waitcnt lgkmcnt(0)
    v_mfma_f32_32x32x16_bf16 v[94:109], v[126:129], v[76:79], 0
    v_exp_f32 v115, v115
    v_exp_f32 v116, v116
    v_exp_f32 v117, v117
    v_mfma_f32_32x32x16_bf16 v[150:165], v[198:201], v[206:209], v[150:165]
    v_exp_f32 v118, v118
    v_exp_f32 v119, v119
    v_exp_f32 v120, v120
    v_smfmac_f32_32x32x32_bf16 v[60:75], v[142:145], v[110:117], v22
    ds_read_b64 v[230:231], v26 offset:224
    ds_read_b64 v[232:233], v26 offset:232
    v_exp_f32 v121, v121
    v_exp_f32 v122, v122
    v_exp_f32 v123, v123
    v_mfma_f32_32x32x16_bf16 v[166:181], v[202:205], v[206:209], v[166:181]
    v_exp_f32 v124, v124
    v_exp_f32 v125, v125
    v_exp_f32 v94, v94
    v_exp_f32 v95, v95
    v_smfmac_f32_32x32x32_bf16 v[60:75], v[146:149], v[118:125], v22
    ds_read_b128 v[138:141], v23 offset:18720
    s_waitcnt vmcnt(2)
    s_mov_b32 s82, 400000
L_poll2:
    v_and_b32 v8, -16, v84
    v_cmp_ne_u32 vcc, s7, v8
    s_nop 4
    s_cbranch_vccz L_poll2_ok
    buffer_load_dword v84, v43, s[8:11], s27 offen sc1
    s_waitcnt vmcnt(0)
    s_sub_u32 s82, s82, 1
    s_cmp_lg_u32 s82, 0
    s_cbranch_scc1 L_poll2
L_poll2_ok:
    s_lshl_b32 s72, s3, 2
    s_add_u32 s72, s72, 163584
    v_mov_b32 v8, s72
    ds_write_b32 v8, v84
    ds_read_b128 v[238:241], v27 offset:2832
    ds_read_b128 v[242:245], v27 offset:272
    v_exp_f32 v96, v96
    v_exp_f32 v97, v97
    v_exp_f32 v98, v98
    v_mfma_f32_32x32x16_bf16 v[110:125], v[126:129], v[80:83], 0
    ds_read_b128 v[146:149], v25 offset:18720
    v_exp_f32 v99, v99
    v_exp_f32 v100, v100
    v_exp_f32 v101, v101
    v_mfma_f32_32x32x16_bf16 v[166:181], v[214:217], v[226:229], v[166:181]
    ds_read_b64 v[234:235], v26 offset:2272
    ds_read_b64 v[236:237], v26 offset:2280
    v_exp_f32 v102, v102
    v_exp_f32 v103, v103
    v_exp_f32 v104, v104
    v_smfmac_f32_32x32x32_bf16 v[44:59], v[130:133], v[94:101], v22
    ds_read_b128 v[142:145], v24 offset:18720
    v_exp_f32 v105, v105
    v_exp_f32 v106, v106
    v_exp_f32 v107, v107
    v_mfma_f32_32x32x16_bf16 v[150:165], v[214:217], v[222:225], v[150:165]
    v_exp_f32 v108, v108
    v_exp_f32 v109, v109
    s_setprio 2
    v_exp_f32 v110, v110
    v_exp_f32 v111, v111
    v_smfmac_f32_32x32x32_bf16 v[44:59], v[134:137], v[102:109], v22
    v_exp_f32 v112, v112
    v_exp_f32 v113, v113
    v_exp_f32 v114, v114
    s_waitcnt lgkmcnt(0)
    v_mfma_f32_32x32x16_bf16 v[94:109], v[138:141], v[76:79], 0
    v_exp_f32 v115, v115
    v_exp_f32 v116, v116
    v_exp_f32 v117, v117
    v_mfma_f32_32x32x16_bf16 v[166:181], v[218:221], v[222:225], v[166:181]
    v_exp_f32 v118, v118
    v_exp_f32 v119, v119
    v_exp_f32 v120, v120
    v_smfmac_f32_32x32x32_bf16 v[60:75], v[130:133], v[110:117], v22
    ds_read_b64 v[182:183], v26 offset:256
    ds_read_b64 v[184:185], v26 offset:264
    v_exp_f32 v121, v121
    v_exp_f32 v122, v122
    v_exp_f32 v123, v123
    v_mfma_f32_32x32x16_bf16 v[166:181], v[230:233], v[242:245], v[166:181]
    ds_read_b128 v[190:193], v27 offset:2880
    ds_read_b128 v[194:197], v27 offset:320
    v_exp_f32 v124, v124
    v_exp_f32 v125, v125
    v_exp_f32 v94, v94
    v_exp_f32 v95, v95
    v_smfmac_f32_32x32x32_bf16 v[60:75], v[134:137], v[118:125], v22
    ds_read_b128 v[126:129], v23 offset:20800
    ds_read_b64 v[186:187], v26 offset:2304
    ds_read_b64 v[188:189], v26 offset:2312
    s_lshr_b32 s72, s2, 3
    s_lshl_b32 s72, s72, 3
    s_add_u32 s72, s72, s3
    s_lshl_b32 s72, s72, 11
    v_lshrrev_b32 v7, 2, v1
    v_lshlrev_b32 v7, 7, v7
    buffer_load_dword v7, v7, s[60:63], s72 offen
    v_exp_f32 v96, v96
    v_exp_f32 v97, v97
    v_exp_f32 v98, v98
    v_mfma_f32_32x32x16_bf16 v[110:125], v[138:141], v[80:83], 0
    ds_read_b128 v[134:137], v25 offset:20800
    ds_read_b64 v[198:199], v26 offset:288
    ds_read_b64 v[200:201], v26 offset:296
    v_exp_f32 v99, v99
    v_exp_f32 v100, v100
    v_exp_f32 v101, v101
    v_mfma_f32_32x32x16_bf16 v[150:165], v[230:233], v[238:241], v[150:165]
    ds_read_b128 v[206:209], v27 offset:2912
    ds_read_b128 v[210:213], v27 offset:352
    v_exp_f32 v102, v102
    v_exp_f32 v103, v103
    v_exp_f32 v104, v104
    v_smfmac_f32_32x32x32_bf16 v[44:59], v[142:145], v[94:101], v22
    ds_read_b128 v[130:133], v24 offset:20800
    ds_read_b64 v[202:203], v26 offset:2336
    ds_read_b64 v[204:205], v26 offset:2344
    v_exp_f32 v105, v105
    v_exp_f32 v106, v106
    v_exp_f32 v107, v107
    v_mfma_f32_32x32x16_bf16 v[166:181], v[234:237], v[238:241], v[166:181]
    v_exp_f32 v108, v108
    v_exp_f32 v109, v109
    s_setprio 1
    v_exp_f32 v110, v110
    v_exp_f32 v111, v111
    v_smfmac_f32_32x32x32_bf16 v[44:59], v[146:149], v[102:109], v22
    v_exp_f32 v112, v112
    v_exp_f32 v113, v113
    v_exp_f32 v114, v114
    s_waitcnt lgkmcnt(0)
    v_mfma_f32_32x32x16_bf16 v[94:109], v[126:129], v[76:79], 0
    v_exp_f32 v115, v115
    v_exp_f32 v116, v116
    v_exp_f32 v117, v117
    v_mfma_f32_32x32x16_bf16 v[166:181], v[182:185], v[194:197], v[166:181]
    v_exp_f32 v118, v118
    v_exp_f32 v119, v119
    v_exp_f32 v120, v120
    v_smfmac_f32_32x32x32_bf16 v[60:75], v[142:145], v[110:117], v22
    ds_read_b64 v[214:215], v26 offset:320
    ds_read_b64 v[216:217], v26 offset:328
    v_exp_f32 v121, v121
    v_exp_f32 v122, v122
    v_exp_f32 v123, v123
    v_mfma_f32_32x32x16_bf16 v[150:165], v[182:185], v[190:193], v[150:165]
    v_exp_f32 v124, v124
    v_exp_f32 v125, v125
    v_exp_f32 v94, v94
    v_exp_f32 v95, v95
    v_smfmac_f32_32x32x32_bf16 v[60:75], v[146:149], v[118:125], v22
    ds_read_b128 v[138:141], v23 offset:22880
    ds_read_b128 v[222:225], v27 offset:2960
    ds_read_b128 v[226:229], v27 offset:400
    v_exp_f32 v96, v96
    v_exp_f32 v97, v97
    v_exp_f32 v98, v98
    v_mfma_f32_32x32x16_bf16 v[110:125], v[126:129], v[80:83], 0
    ds_read_b128 v[146:149], v25 offset:22880
    v_exp_f32 v99, v99
    v_exp_f32 v100, v100
    v_exp_f32 v101, v101
    v_mfma_f32_32x32x16_bf16 v[166:181], v[186:189], v[190:193], v[166:181]
    ds_read_b64 v[218:219], v26 offset:2368
    ds_read_b64 v[220:221], v26 offset:2376
    v_exp_f32 v102, v102
    v_exp_f32 v103, v103
    v_exp_f32 v104, v104
    v_smfmac_f32_32x32x32_bf16 v[44:59], v[130:133], v[94:101], v22
    ds_read_b128 v[142:145], v24 offset:22880
    v_exp_f32 v105, v105
    v_exp_f32 v106, v106
    v_exp_f32 v107, v107
    v_mfma_f32_32x32x16_bf16 v[166:181], v[198:201], v[210:213], v[166:181]
    v_exp_f32 v108, v108
    v_exp_f32 v109, v109
    s_setprio 0
    v_exp_f32 v110, v110
    v_exp_f32 v111, v111
    v_smfmac_f32_32x32x32_bf16 v[44:59], v[134:137], v[102:109], v22
    v_exp_f32 v112, v112
    v_exp_f32 v113, v113
    v_exp_f32 v114, v114
    s_waitcnt lgkmcnt(0)
    v_mfma_f32_32x32x16_bf16 v[94:109], v[138:141], v[76:79], 0
    v_exp_f32 v115, v115
    v_exp_f32 v116, v116
    v_exp_f32 v117, v117
    v_mfma_f32_32x32x16_bf16 v[150:165], v[198:201], v[206:209], v[150:165]
    v_exp_f32 v118, v118
    v_exp_f32 v119, v119
    v_exp_f32 v120, v120
    v_smfmac_f32_32x32x32_bf16 v[60:75], v[130:133], v[110:117], v22
    ds_read_b64 v[230:231], v26 offset:352
    ds_read_b64 v[232:233], v26 offset:360
    v_exp_f32 v121, v121
    v_exp_f32 v122, v122
    v_exp_f32 v123, v123
    v_mfma_f32_32x32x16_bf16 v[166:181], v[202:205], v[206:209], v[166:181]
    v_exp_f32 v124, v124
    v_exp_f32 v125, v125
    s_waitcnt vmcnt(1)
    s_barrier
    s_setprio 3
    v_exp_f32 v94, v94
    v_exp_f32 v95, v95
    v_smfmac_f32_32x32x32_bf16 v[60:75], v[134:137], v[118:125], v22
    ds_read_b128 v[126:129], v23 offset:0
    ds_read_b128 v[238:241], v27 offset:2992
    ds_read_b128 v[242:245], v27 offset:432
    v_exp_f32 v96, v96
    v_exp_f32 v97, v97
    v_exp_f32 v98, v98
    v_mfma_f32_32x32x16_bf16 v[110:125], v[138:141], v[80:83], 0
    ds_read_b128 v[134:137], v25 offset:0
    s_add_u32 m0, s51, 16640
    s_nop 0
    buffer_load_dwordx4 v20, s[8:11], s50 offen sc1 lds
    v_exp_f32 v99, v99
    v_exp_f32 v100, v100
    v_exp_f32 v101, v101
    v_mfma_f32_32x32x16_bf16 v[166:181], v[214:217], v[226:229], v[166:181]
    ds_read_b64 v[234:235], v26 offset:2400
    ds_read_b64 v[236:237], v26 offset:2408
    v_exp_f32 v102, v102
    v_exp_f32 v103, v103
    v_exp_f32 v104, v104
    v_smfmac_f32_32x32x32_bf16 v[44:59], v[142:145], v[94:101], v22
    ds_read_b128 v[130:133], v24 offset:0
    buffer_load_dwordx4 v20, s[8:11], s50 offen offset:1024 sc1 lds
    s_add_u32 s50, s50, 16384
    s_and_b32 s50, s50, 0x1ffff
    v_exp_f32 v105, v105
    v_exp_f32 v106, v106
    v_exp_f32 v107, v107
    v_mfma_f32_32x32x16_bf16 v[150:165], v[214:217], v[222:225], v[150:165]
    v_exp_f32 v108, v108
    v_exp_f32 v109, v109
    v_exp_f32 v110, v110
    v_exp_f32 v111, v111
    v_smfmac_f32_32x32x32_bf16 v[44:59], v[146:149], v[102:109], v22
    v_exp_f32 v112, v112
    v_exp_f32 v113, v113
    v_exp_f32 v114, v114
    s_waitcnt lgkmcnt(0)
    v_mfma_f32_32x32x16_bf16 v[94:109], v[126:129], v[76:79], 0
    v_exp_f32 v115, v115
    v_exp_f32 v116, v116
    v_exp_f32 v117, v117
    v_mfma_f32_32x32x16_bf16 v[166:181], v[218:221], v[222:225], v[166:181]
    v_exp_f32 v118, v118
    v_exp_f32 v119, v119
    v_exp_f32 v120, v120
    v_smfmac_f32_32x32x32_bf16 v[60:75], v[142:145], v[110:117], v22
    ds_read_b64 v[182:183], v26 offset:384
    ds_read_b64 v[184:185], v26 offset:392
    v_exp_f32 v121, v121
    v_exp_f32 v122, v122
    v_exp_f32 v123, v123
    v_mfma_f32_32x32x16_bf16 v[166:181], v[230:233], v[242:245], v[166:181]
    ds_read_b128 v[190:193], v27 offset:3040
    ds_read_b128 v[194:197], v27 offset:480
    v_exp_f32 v124, v124
    v_exp_f32 v125, v125
    v_exp_f32 v94, v94
    v_exp_f32 v95, v95
    v_smfmac_f32_32x32x32_bf16 v[60:75], v[146:149], v[118:125], v22
    ds_read_b128 v[138:141], v23 offset:2080
    ds_read_b64 v[186:187], v26 offset:2432
    ds_read_b64 v[188:189], v26 offset:2440
    buffer_load_dword v6, v4, s[8:11], s28 offen
    v_exp_f32 v96, v96
    v_exp_f32 v97, v97
    v_exp_f32 v98, v98
    v_mfma_f32_32x32x16_bf16 v[110:125], v[126:129], v[80:83], 0
    ds_read_b128 v[146:149], v25 offset:2080
    ds_read_b64 v[198:199], v26 offset:416
    ds_read_b64 v[200:201], v26 offset:424
    v_exp_f32 v99, v99
    v_exp_f32 v100, v100
    v_exp_f32 v101, v101
    v_mfma_f32_32x32x16_bf16 v[150:165], v[230:233], v[238:241], v[150:165]
    ds_read_b128 v[206:209], v27 offset:3072
    ds_read_b128 v[210:213], v27 offset:512
    v_exp_f32 v102, v102
    v_exp_f32 v103, v103
    v_exp_f32 v104, v104
    v_smfmac_f32_32x32x32_bf16 v[44:59], v[130:133], v[94:101], v22
    ds_read_b128 v[142:145], v24 offset:2080
    ds_read_b64 v[202:203], v26 offset:2464
    ds_read_b64 v[204:205], v26 offset:2472
    v_exp_f32 v105, v105
    v_exp_f32 v106, v106
    v_exp_f32 v107, v107
    v_mfma_f32_32x32x16_bf16 v[166:181], v[234:237], v[238:241], v[166:181]
    v_exp_f32 v108, v108
    v_exp_f32 v109, v109
    s_setprio 2
    v_exp_f32 v110, v110
    v_exp_f32 v111, v111
    v_smfmac_f32_32x32x32_bf16 v[44:59], v[134:137], v[102:109], v22
    v_exp_f32 v112, v112
    v_exp_f32 v113, v113
    v_exp_f32 v114, v114
    s_waitcnt lgkmcnt(0)
    v_mfma_f32_32x32x16_bf16 v[94:109], v[138:141], v[76:79], 0
    v_exp_f32 v115, v115
    v_exp_f32 v116, v116
    v_exp_f32 v117, v117
    v_mfma_f32_32x32x16_bf16 v[166:181], v[182:185], v[194:197], v[166:181]
    v_exp_f32 v118, v118
    v_exp_f32 v119, v119
    v_exp_f32 v120, v120
    v_smfmac_f32_32x32x32_bf16 v[60:75], v[130:133], v[110:117], v22
    ds_read_b64 v[214:215], v26 offset:448
    ds_read_b64 v[216:217], v26 offset:456
    v_exp_f32 v121, v121
    v_exp_f32 v122, v122
    v_exp_f32 v123, v123
    v_mfma_f32_32x32x16_bf16 v[150:165], v[182:185], v[190:193], v[150:165]
    v_exp_f32 v124, v124
    v_exp_f32 v125, v125
    v_exp_f32 v94, v94
    v_exp_f32 v95, v95
    v_smfmac_f32_32x32x32_bf16 v[60:75], v[134:137], v[118:125], v22
    ds_read_b128 v[126:129], v23 offset:4160
    ds_read_b128 v[222:225], v27 offset:3120
    ds_read_b128 v[226:229], v27 offset:560
    v_exp_f32 v96, v96
    v_exp_f32 v97, v97
    v_exp_f32 v98, v98
    v_mfma_f32_32x32x16_bf16 v[110:125], v[138:141], v[80:83], 0
    ds_read_b128 v[134:137], v25 offset:4160
    v_exp_f32 v99, v99
    v_exp_f32 v100, v100
    v_exp_f32 v101, v101
    v_mfma_f32_32x32x16_bf16 v[166:181], v[186:189], v[190:193], v[166:181]
    ds_read_b64 v[218:219], v26 offset:2496
    ds_read_b64 v[220:221], v26 offset:2504
    v_exp_f32 v102, v102
    v_exp_f32 v103, v103
    v_exp_f32 v104, v104
    v_smfmac_f32_32x32x32_bf16 v[44:59], v[142:145], v[94:101], v22
    ds_read_b128 v[130:133], v24 offset:4160
    v_exp_f32 v105, v105
    v_exp_f32 v106, v106
    v_exp_f32 v107, v107
    v_mfma_f32_32x32x16_bf16 v[166:181], v[198:201], v[210:213], v[166:181]
    v_exp_f32 v108, v108
    v_exp_f32 v109, v109
    s_setprio 1
    v_exp_f32 v110, v110
    v_exp_f32 v111, v111
    v_smfmac_f32_32x32x32_bf16 v[44:59], v[146:149], v[102:109], v22
    v_exp_f32 v112, v112
    v_exp_f32 v113, v113
    v_exp_f32 v114, v114
    s_waitcnt lgkmcnt(0)
    v_mfma_f32_32x32x16_bf16 v[94:109], v[126:129], v[76:79], 0
    v_exp_f32 v115, v115
    v_exp_f32 v116, v116
    v_exp_f32 v117, v117
    v_mfma_f32_32x32x16_bf16 v[150:165], v[198:201], v[206:209], v[150:165]
    v_exp_f32 v118, v118
    v_exp_f32 v119, v119
    v_exp_f32 v120, v120
    v_smfmac_f32_32x32x32_bf16 v[60:75], v[142:145], v[110:117], v22
    ds_read_b64 v[230:231], v26 offset:480
    ds_read_b64 v[232:233], v26 offset:488
    v_exp_f32 v121, v121
    v_exp_f32 v122, v122
    v_exp_f32 v123, v123
    v_mfma_f32_32x32x16_bf16 v[166:181], v[202:205], v[206:209], v[166:181]
    v_exp_f32 v124, v124
    v_exp_f32 v125, v125
    v_exp_f32 v94, v94
    v_exp_f32 v95, v95
    v_smfmac_f32_32x32x32_bf16 v[60:75], v[146:149], v[118:125], v22
    ds_read_b128 v[138:141], v23 offset:6240
    ds_read_b128 v[238:241], v27 offset:3152
    ds_read_b128 v[242:245], v27 offset:592
    v_exp_f32 v96, v96
    v_exp_f32 v97, v97
    v_exp_f32 v98, v98
    v_mfma_f32_32x32x16_bf16 v[110:125], v[126:129], v[80:83], 0
    ds_read_b128 v[146:149], v25 offset:6240
    v_exp_f32 v99, v99
    v_exp_f32 v100, v100
    v_exp_f32 v101, v101
    v_mfma_f32_32x32x16_bf16 v[166:181], v[214:217], v[226:229], v[166:181]
    ds_read_b64 v[234:235], v26 offset:2528
    ds_read_b64 v[236:237], v26 offset:2536
    v_exp_f32 v102, v102
    v_exp_f32 v103, v103
    v_exp_f32 v104, v104
    v_smfmac_f32_32x32x32_bf16 v[44:59], v[130:133], v[94:101], v22
    ds_read_b128 v[142:145], v24 offset:6240
    v_exp_f32 v105, v105
    v_exp_f32 v106, v106
    v_exp_f32 v107, v107
    v_mfma_f32_32x32x16_bf16 v[150:165], v[214:217], v[222:225], v[150:165]
    v_exp_f32 v108, v108
    v_exp_f32 v109, v109
    s_setprio 0
    v_exp_f32 v110, v110
    v_exp_f32 v111, v111
    v_smfmac_f32_32x32x32_bf16 v[44:59], v[134:137], v[102:109], v22
    v_exp_f32 v112, v112
    v_exp_f32 v113, v113
    v_exp_f32 v114, v114
    s_waitcnt lgkmcnt(0)
    v_mfma_f32_32x32x16_bf16 v[94:109], v[138:141], v[76:79], 0
    v_exp_f32 v115, v115
    v_exp_f32 v116, v116
    v_exp_f32 v117, v117
    v_mfma_f32_32x32x16_bf16 v[166:181], v[218:221], v[222:225], v[166:181]
    v_exp_f32 v118, v118
    v_exp_f32 v119, v119
    v_exp_f32 v120, v120
    v_smfmac_f32_32x32x32_bf16 v[60:75], v[130:133], v[110:117], v22
    v_exp_f32 v121, v121
    v_exp_f32 v122, v122
    v_exp_f32 v123, v123
    v_mfma_f32_32x32x16_bf16 v[166:181], v[230:233], v[242:245], v[166:181]
    v_exp_f32 v124, v124
    v_exp_f32 v125, v125
    s_waitcnt vmcnt(1)
    s_barrier
    s_setprio 3
    v_exp_f32 v94, v94
    v_exp_f32 v95, v95
    v_smfmac_f32_32x32x32_bf16 v[60:75], v[134:137], v[118:125], v22
    ds_read_b128 v[126:129], v23 offset:16640
    v_exp_f32 v96, v96
    v_exp_f32 v97, v97
    v_exp_f32 v98, v98
    v_mfma_f32_32x32x16_bf16 v[110:125], v[138:141], v[80:83], 0
    ds_read_b128 v[134:137], v25 offset:16640
    s_mov_b32 m0, s51
    s_nop 0
    buffer_load_dwordx4 v20, s[8:11], s50 offen sc1 lds
    v_exp_f32 v99, v99
    v_exp_f32 v100, v100
    v_exp_f32 v101, v101
    v_mfma_f32_32x32x16_bf16 v[150:165], v[230:233], v[238:241], v[150:165]
    v_exp_f32 v102, v102
    v_exp_f32 v103, v103
    v_exp_f32 v104, v104
    v_smfmac_f32_32x32x32_bf16 v[44:59], v[142:145], v[94:101], v22
    ds_read_b128 v[130:133], v24 offset:16640
    buffer_load_dwordx4 v20, s[8:11], s50 offen offset:1024 sc1 lds
    s_add_u32 s50, s50, 16384
    s_and_b32 s50, s50, 0x1ffff
    v_exp_f32 v105, v105
    v_exp_f32 v106, v106
    v_exp_f32 v107, v107
    v_mfma_f32_32x32x16_bf16 v[166:181], v[234:237], v[238:241], v[166:181]
    v_exp_f32 v108, v108
    v_exp_f32 v109, v109
    v_exp_f32 v110, v110
    v_exp_f32 v111, v111
    v_smfmac_f32_32x32x32_bf16 v[44:59], v[146:149], v[102:109], v22
    v_exp_f32 v112, v112
    v_exp_f32 v113, v113
    v_exp_f32 v114, v114
    s_waitcnt lgkmcnt(0)
    v_mfma_f32_32x32x16_bf16 v[94:109], v[126:129], v[76:79], 0
    v_exp_f32 v115, v115
    v_exp_f32 v116, v116
    v_exp_f32 v117, v117
    v_exp_f32 v118, v118
    v_exp_f32 v119, v119
    v_exp_f32 v120, v120
    v_smfmac_f32_32x32x32_bf16 v[60:75], v[142:145], v[110:117], v22
    ds_write_b128 v29, v[150:153] offset:0
    v_exp_f32 v121, v121
    v_exp_f32 v122, v122
    v_exp_f32 v123, v123
    v_exp_f32 v124, v124
    v_exp_f32 v125, v125
    v_exp_f32 v94, v94
    v_exp_f32 v95, v95
    v_smfmac_f32_32x32x32_bf16 v[60:75], v[146:149], v[118:125], v22
    ds_read_b128 v[138:141], v23 offset:18720
    v_exp_f32 v96, v96
    v_exp_f32 v97, v97
    v_exp_f32 v98, v98
    v_mfma_f32_32x32x16_bf16 v[110:125], v[126:129], v[80:83], 0
    ds_read_b128 v[146:149], v25 offset:18720
    ds_write_b128 v29, v[154:157] offset:32
    v_exp_f32 v99, v99
    v_exp_f32 v100, v100
    v_exp_f32 v101, v101
    v_exp_f32 v102, v102
    v_exp_f32 v103, v103
    v_exp_f32 v104, v104
    v_smfmac_f32_32x32x32_bf16 v[44:59], v[130:133], v[94:101], v22
    ds_read_b128 v[142:145], v24 offset:18720
    v_exp_f32 v105, v105
    v_exp_f32 v106, v106
    v_exp_f32 v107, v107
    v_exp_f32 v108, v108
    v_exp_f32 v109, v109
    s_setprio 2
    v_exp_f32 v110, v110
    v_exp_f32 v111, v111
    v_smfmac_f32_32x32x32_bf16 v[44:59], v[134:137], v[102:109], v22
    ds_write_b128 v29, v[158:161] offset:64
    v_exp_f32 v112, v112
    v_exp_f32 v113, v113
    v_exp_f32 v114, v114
    s_waitcnt lgkmcnt(0)
    v_mfma_f32_32x32x16_bf16 v[94:109], v[138:141], v[76:79], 0
    v_exp_f32 v115, v115
    v_exp_f32 v116, v116
    v_exp_f32 v117, v117
    v_exp_f32 v118, v118
    v_exp_f32 v119, v119
    v_exp_f32 v120, v120
    v_smfmac_f32_32x32x32_bf16 v[60:75], v[130:133], v[110:117], v22
    ds_write_b128 v29, v[162:165] offset:96
    v_exp_f32 v121, v121
    v_exp_f32 v122, v122
    v_exp_f32 v123, v123
    v_exp_f32 v124, v124
    v_exp_f32 v125, v125
    v_exp_f32 v94, v94
    v_exp_f32 v95, v95
    v_smfmac_f32_32x32x32_bf16 v[60:75], v[134:137], v[118:125], v22
    ds_read_b128 v[126:129], v23 offset:20800
    v_exp_f32 v96, v96
    v_exp_f32 v97, v97
    v_exp_f32 v98, v98
    v_mfma_f32_32x32x16_bf16 v[110:125], v[138:141], v[80:83], 0
    ds_read_b128 v[134:137], v25 offset:20800
    ds_write_b128 v29, v[166:169] offset:4608
    v_exp_f32 v99, v99
    v_exp_f32 v100, v100
    v_exp_f32 v101, v101
    v_exp_f32 v102, v102
    v_exp_f32 v103, v103
    v_exp_f32 v104, v104
    v_smfmac_f32_32x32x32_bf16 v[44:59], v[142:145], v[94:101], v22
    ds_read_b128 v[130:133], v24 offset:20800
    v_exp_f32 v105, v105
    v_exp_f32 v106, v106
    v_exp_f32 v107, v107
    v_exp_f32 v108, v108
    v_exp_f32 v109, v109
    s_setprio 1
    v_exp_f32 v110, v110
    v_exp_f32 v111, v111
    v_smfmac_f32_32x32x32_bf16 v[44:59], v[146:149], v[102:109], v22
    ds_write_b128 v29, v[170:173] offset:4640
    v_exp_f32 v112, v112
    v_exp_f32 v113, v113
    v_exp_f32 v114, v114
    s_waitcnt lgkmcnt(0)
    v_mfma_f32_32x32x16_bf16 v[94:109], v[126:129], v[76:79], 0
    v_exp_f32 v115, v115
    v_exp_f32 v116, v116
    v_exp_f32 v117, v117
    v_exp_f32 v118, v118
    v_exp_f32 v119, v119
    v_exp_f32 v120, v120
    v_smfmac_f32_32x32x32_bf16 v[60:75], v[142:145], v[110:117], v22
    ds_write_b128 v29, v[174:177] offset:4672
    v_exp_f32 v121, v121
    v_exp_f32 v122, v122
    v_exp_f32 v123, v123
    v_exp_f32 v124, v124
    v_exp_f32 v125, v125
    v_exp_f32 v94, v94
    v_exp_f32 v95, v95
    v_smfmac_f32_32x32x32_bf16 v[60:75], v[146:149], v[118:125], v22
    ds_read_b128 v[138:141], v23 offset:22880
    v_exp_f32 v96, v96
    v_exp_f32 v97, v97
    v_exp_f32 v98, v98
    v_mfma_f32_32x32x16_bf16 v[110:125], v[126:129], v[80:83], 0
    ds_read_b128 v[146:149], v25 offset:22880
    ds_write_b128 v29, v[178:181] offset:4704
    v_exp_f32 v99, v99
    v_exp_f32 v100, v100
    v_exp_f32 v101, v101
    v_exp_f32 v102, v102
    v_exp_f32 v103, v103
    v_exp_f32 v104, v104
    v_smfmac_f32_32x32x32_bf16 v[44:59], v[130:133], v[94:101], v22
    ds_read_b128 v[142:145], v24 offset:22880
    v_exp_f32 v105, v105
    v_exp_f32 v106, v106
    v_exp_f32 v107, v107
    v_exp_f32 v108, v108
    v_exp_f32 v109, v109
    s_setprio 0
    v_exp_f32 v110, v110
    v_exp_f32 v111, v111
    v_smfmac_f32_32x32x32_bf16 v[44:59], v[134:137], v[102:109], v22
    v_exp_f32 v112, v112
    v_exp_f32 v113, v113
    v_exp_f32 v114, v114
    s_waitcnt lgkmcnt(0)
    v_mfma_f32_32x32x16_bf16 v[94:109], v[138:141], v[76:79], 0
    v_exp_f32 v115, v115
    v_exp_f32 v116, v116
    v_exp_f32 v117, v117
    v_exp_f32 v118, v118
    v_exp_f32 v119, v119
    v_exp_f32 v120, v120
    v_smfmac_f32_32x32x32_bf16 v[60:75], v[130:133], v[110:117], v22
    v_exp_f32 v121, v121
    v_exp_f32 v122, v122
    v_exp_f32 v123, v123
    v_exp_f32 v124, v124
    v_exp_f32 v125, v125
    s_waitcnt vmcnt(0)
    s_barrier
    s_setprio 3
    v_exp_f32 v94, v94
    v_exp_f32 v95, v95
    v_smfmac_f32_32x32x32_bf16 v[60:75], v[134:137], v[118:125], v22
    ds_read_b128 v[126:129], v23 offset:0
    ds_read_b128 v[182:185], v30 offset:0
    ds_read_b128 v[186:189], v30 offset:9216
    v_exp_f32 v96, v96
    v_exp_f32 v97, v97
    v_exp_f32 v98, v98
    v_mfma_f32_32x32x16_bf16 v[110:125], v[138:141], v[80:83], 0
    ds_read_b128 v[134:137], v25 offset:0
    s_add_u32 m0, s51, 16640
    s_nop 0
    buffer_load_dwordx4 v20, s[8:11], s50 offen sc1 lds
    ds_read_b128 v[190:193], v30 offset:18432
    v_exp_f32 v99, v99
    v_exp_f32 v100, v100
    v_exp_f32 v101, v101
    v_exp_f32 v102, v102
    v_exp_f32 v103, v103
    v_exp_f32 v104, v104
    v_smfmac_f32_32x32x32_bf16 v[44:59], v[142:145], v[94:101], v22
    ds_read_b128 v[130:133], v24 offset:0
    buffer_load_dwordx4 v20, s[8:11], s50 offen offset:1024 sc1 lds
    s_add_u32 s50, s50, 16384
    s_and_b32 s50, s50, 0x1ffff
    ds_read_b128 v[194:197], v30 offset:27648
    v_exp_f32 v105, v105
    v_exp_f32 v106, v106
    v_exp_f32 v107, v107
    v_exp_f32 v108, v108
    v_exp_f32 v109, v109
    v_exp_f32 v110, v110
    v_exp_f32 v111, v111
    v_smfmac_f32_32x32x32_bf16 v[44:59], v[146:149], v[102:109], v22
    v_exp_f32 v112, v112
    v_exp_f32 v113, v113
    v_exp_f32 v114, v114
    s_waitcnt lgkmcnt(0)
    v_mfma_f32_32x32x16_bf16 v[94:109], v[126:129], v[76:79], 0
    v_exp_f32 v115, v115
    v_exp_f32 v116, v116
    v_exp_f32 v117, v117
    v_exp_f32 v118, v118
    v_exp_f32 v119, v119
    v_exp_f32 v120, v120
    v_smfmac_f32_32x32x32_bf16 v[60:75], v[142:145], v[110:117], v22
    ds_read_b128 v[198:201], v30 offset:36864
    v_exp_f32 v121, v121
    v_exp_f32 v122, v122
    v_exp_f32 v123, v123
    v_exp_f32 v124, v124
    v_exp_f32 v125, v125
    v_exp_f32 v94, v94
    v_exp_f32 v95, v95
    v_smfmac_f32_32x32x32_bf16 v[60:75], v[146:149], v[118:125], v22
    ds_read_b128 v[138:141], v23 offset:2080
    ds_read_b128 v[202:205], v30 offset:46080
    v_exp_f32 v96, v96
    v_exp_f32 v97, v97
    v_exp_f32 v98, v98
    v_mfma_f32_32x32x16_bf16 v[110:125], v[126:129], v[80:83], 0
    ds_read_b128 v[146:149], v25 offset:2080
    ds_read_b128 v[206:209], v30 offset:55296
    v_exp_f32 v99, v99
    v_exp_f32 v100, v100
    v_exp_f32 v101, v101
    v_exp_f32 v102, v102
    v_exp_f32 v103, v103
    v_exp_f32 v104, v104
    v_smfmac_f32_32x32x32_bf16 v[44:59], v[130:133], v[94:101], v22
    ds_read_b128 v[142:145], v24 offset:2080
    ds_read_b128 v[210:213], v30 offset:64512
    v_exp_f32 v105, v105
    v_exp_f32 v106, v106
    v_exp_f32 v107, v107
    v_exp_f32 v108, v108
    v_exp_f32 v109, v109
    s_setprio 2
    v_exp_f32 v110, v110
    v_exp_f32 v111, v111
    v_smfmac_f32_32x32x32_bf16 v[44:59], v[134:137], v[102:109], v22
    v_exp_f32 v112, v112
    v_exp_f32 v113, v113
    v_exp_f32 v114, v114
    s_waitcnt lgkmcnt(0)
    v_mfma_f32_32x32x16_bf16 v[94:109], v[138:141], v[76:79], 0
    v_exp_f32 v115, v115
    v_add_f32 v182, v182, v186
    v_exp_f32 v116, v116
    v_add_f32 v183, v183, v187
    v_exp_f32 v117, v117
    v_add_f32 v184, v184, v188
    v_exp_f32 v118, v118
    v_add_f32 v185, v185, v189
    v_exp_f32 v119, v119
    v_exp_f32 v120, v120
    v_smfmac_f32_32x32x32_bf16 v[60:75], v[130:133], v[110:117], v22
    v_add_f32 v190, v190, v194
    v_exp_f32 v121, v121
    v_add_f32 v191, v191, v195
    v_exp_f32 v122, v122
    v_add_f32 v192, v192, v196
    v_exp_f32 v123, v123
    v_exp_f32 v124, v124
    v_add_f32 v193, v193, v197
    v_exp_f32 v125, v125
    v_add_f32 v182, v182, v190
    v_exp_f32 v94, v94
    v_add_f32 v183, v183, v191
    v_exp_f32 v95, v95
    v_smfmac_f32_32x32x32_bf16 v[60:75], v[134:137], v[118:125], v22
    ds_read_b128 v[126:129], v23 offset:4160
    v_add_f32 v184, v184, v192
    v_exp_f32 v96, v96
    v_exp_f32 v97, v97
    v_add_f32 v185, v185, v193
    v_exp_f32 v98, v98
    v_mfma_f32_32x32x16_bf16 v[110:125], v[138:141], v[80:83], 0
    ds_read_b128 v[134:137], v25 offset:4160
    v_add_f32 v198, v198, v202
    v_exp_f32 v99, v99
    v_add_f32 v199, v199, v203
    v_exp_f32 v100, v100
    v_exp_f32 v101, v101
    v_add_f32 v200, v200, v204
    v_exp_f32 v102, v102
    v_add_f32 v201, v201, v205
    v_exp_f32 v103, v103
    v_add_f32 v206, v206, v210
    v_exp_f32 v104, v104
    v_smfmac_f32_32x32x32_bf16 v[44:59], v[142:145], v[94:101], v22
    ds_read_b128 v[130:133], v24 offset:4160
    v_add_f32 v207, v207, v211
    v_exp_f32 v105, v105
    v_exp_f32 v106, v106
    v_add_f32 v208, v208, v212
    v_exp_f32 v107, v107
    v_add_f32 v209, v209, v213
    v_exp_f32 v108, v108
    v_add_f32 v198, v198, v206
    v_exp_f32 v109, v109
    s_setprio 1
    v_exp_f32 v110, v110
    v_add_f32 v199, v199, v207
    v_exp_f32 v111, v111
    v_smfmac_f32_32x32x32_bf16 v[44:59], v[146:149], v[102:109], v22
    v_add_f32 v200, v200, v208
    v_exp_f32 v112, v112
    v_add_f32 v201, v201, v209
    v_exp_f32 v113, v113
    v_cvt_pk_bf16_f32 v86, v182, v198
    v_exp_f32 v114, v114
    s_waitcnt lgkmcnt(0)
    v_mfma_f32_32x32x16_bf16 v[94:109], v[126:129], v[76:79], 0
    v_exp_f32 v115, v115
    v_cvt_pk_bf16_f32 v87, v183, v199
    v_exp_f32 v116, v116
    v_cvt_pk_bf16_f32 v88, v184, v200
    v_exp_f32 v117, v117
    v_cvt_pk_bf16_f32 v89, v185, v201
    v_exp_f32 v118, v118
    v_exp_f32 v119, v119
    v_exp_f32 v120, v120
    v_smfmac_f32_32x32x32_bf16 v[60:75], v[142:145], v[110:117], v22
    buffer_store_dwordx4 v[86:89], v32, s[8:11], s18 offen sc1
    v_exp_f32 v121, v121
    v_exp_f32 v122, v122
    v_exp_f32 v123, v123
    v_exp_f32 v124, v124
    v_exp_f32 v125, v125
    v_exp_f32 v94, v94
    v_exp_f32 v95, v95
    v_smfmac_f32_32x32x32_bf16 v[60:75], v[146:149], v[118:125], v22
    ds_read_b128 v[138:141], v23 offset:6240
    v_exp_f32 v96, v96
    v_exp_f32 v97, v97
    v_exp_f32 v98, v98
    v_mfma_f32_32x32x16_bf16 v[110:125], v[126:129], v[80:83], 0
    ds_read_b128 v[146:149], v25 offset:6240
    v_exp_f32 v99, v99
    v_exp_f32 v100, v100
    v_exp_f32 v101, v101
    v_exp_f32 v102, v102
    v_exp_f32 v103, v103
    v_exp_f32 v104, v104
    v_smfmac_f32_32x32x32_bf16 v[44:59], v[130:133], v[94:101], v22
    ds_read_b128 v[142:145], v24 offset:6240
    v_exp_f32 v105, v105
    v_exp_f32 v106, v106
    v_exp_f32 v107, v107
    v_exp_f32 v108, v108
    v_exp_f32 v109, v109
    s_setprio 0
    v_exp_f32 v110, v110
    v_exp_f32 v111, v111
    v_smfmac_f32_32x32x32_bf16 v[44:59], v[134:137], v[102:109], v22
    v_exp_f32 v112, v112
    v_exp_f32 v113, v113
    v_exp_f32 v114, v114
    s_waitcnt lgkmcnt(0)
    v_mfma_f32_32x32x16_bf16 v[94:109], v[138:141], v[76:79], 0
    v_exp_f32 v115, v115
    v_exp_f32 v116, v116
    v_exp_f32 v117, v117
    v_exp_f32 v118, v118
    v_exp_f32 v119, v119
    v_exp_f32 v120, v120
    v_smfmac_f32_32x32x32_bf16 v[60:75], v[130:133], v[110:117], v22
    v_exp_f32 v121, v121
    v_exp_f32 v122, v122
    v_exp_f32 v123, v123
    v_exp_f32 v124, v124
    v_exp_f32 v125, v125
    s_waitcnt vmcnt(1)
    s_barrier
    s_setprio 3
    v_exp_f32 v94, v94
    v_exp_f32 v95, v95
    v_smfmac_f32_32x32x32_bf16 v[60:75], v[134:137], v[118:125], v22
    ds_read_b128 v[126:129], v23 offset:16640
    v_exp_f32 v96, v96
    v_exp_f32 v97, v97
    v_exp_f32 v98, v98
    v_mfma_f32_32x32x16_bf16 v[110:125], v[138:141], v[80:83], 0
    ds_read_b128 v[134:137], v25 offset:16640
    v_exp_f32 v99, v99
    v_exp_f32 v100, v100
    v_exp_f32 v101, v101
    v_exp_f32 v102, v102
    v_exp_f32 v103, v103
    v_exp_f32 v104, v104
    v_smfmac_f32_32x32x32_bf16 v[44:59], v[142:145], v[94:101], v22
    ds_read_b128 v[130:133], v24 offset:16640
    s_mov_b32 m0, s19
    s_add_u32 s19, s19, 1024
    buffer_load_dwordx4 v5, s[60:63], s20 offen lds
    s_add_u32 s20, s20, 8192
    v_exp_f32 v105, v105
    v_exp_f32 v106, v106
    v_exp_f32 v107, v107
    v_exp_f32 v108, v108
    v_exp_f32 v109, v109
    v_exp_f32 v110, v110
    v_exp_f32 v111, v111
    v_smfmac_f32_32x32x32_bf16 v[44:59], v[146:149], v[102:109], v22
    s_mov_b32 m0, s19
    s_add_u32 s19, s19, 1024
    buffer_load_dwordx4 v5, s[60:63], s20 offen lds
    s_add_u32 s20, s20, 8192
    v_exp_f32 v112, v112
    v_exp_f32 v113, v113
    v_exp_f32 v114, v114
    s_waitcnt lgkmcnt(0)
    v_mfma_f32_32x32x16_bf16 v[94:109], v[126:129], v[76:79], 0
    s_mov_b32 m0, s19
    s_add_u32 s19, s19, 1024
    buffer_load_dwordx4 v5, s[60:63], s20 offen lds
    s_add_u32 s20, s20, 8192
    v_exp_f32 v115, v115
    v_exp_f32 v116, v116
    v_exp_f32 v117, v117
    v_exp_f32 v118, v118
    v_exp_f32 v119, v119
    v_exp_f32 v120, v120
    v_smfmac_f32_32x32x32_bf16 v[60:75], v[142:145], v[110:117], v22
    s_mov_b32 m0, s19
    s_add_u32 s19, s19, 1024
    buffer_load_dwordx4 v5, s[60:63], s20 offen lds
    s_add_u32 s20, s20, 8192
    v_exp_f32 v121, v121
    v_exp_f32 v122, v122
    v_exp_f32 v123, v123
    v_exp_f32 v124, v124
    v_exp_f32 v125, v125
    v_exp_f32 v94, v94
    v_exp_f32 v95, v95
    s_waitcnt vmcnt(4)
    v_smfmac_f32_32x32x32_bf16 v[60:75], v[146:149], v[118:125], v22
    ds_read_b128 v[138:141], v23 offset:18720
    s_mov_b64 exec, 1
    buffer_store_dword v11, v19, s[8:11], s23 offen sc1
    s_mov_b64 exec, -1
    v_exp_f32 v96, v96
    v_exp_f32 v97, v97
    v_exp_f32 v98, v98
    v_mfma_f32_32x32x16_bf16 v[110:125], v[126:129], v[80:83], 0
    ds_read_b128 v[146:149], v25 offset:18720
    s_mov_b32 m0, s19
    s_add_u32 s19, s19, 1024
    buffer_load_dwordx4 v5, s[60:63], s20 offen lds
    s_add_u32 s20, s20, 8192
    v_exp_f32 v99, v99
    v_exp_f32 v100, v100
    v_exp_f32 v101, v101
    v_exp_f32 v102, v102
    v_exp_f32 v103, v103
    v_exp_f32 v104, v104
    v_smfmac_f32_32x32x32_bf16 v[44:59], v[130:133], v[94:101], v22
    ds_read_b128 v[142:145], v24 offset:18720
    s_mov_b32 m0, s19
    s_add_u32 s19, s19, 1024
    buffer_load_dwordx4 v5, s[60:63], s20 offen lds
    s_add_u32 s20, s20, 8192
    v_exp_f32 v105, v105
    v_exp_f32 v106, v106
    v_exp_f32 v107, v107
    v_exp_f32 v108, v108
    v_exp_f32 v109, v109
    v_exp_f32 v110, v110
    v_exp_f32 v111, v111
    v_smfmac_f32_32x32x32_bf16 v[44:59], v[134:137], v[102:109], v22
    s_mov_b32 m0, s19
    s_add_u32 s19, s19, 1024
    buffer_load_dwordx4 v5, s[60:63], s20 offen lds
    s_add_u32 s20, s20, 8192
    v_exp_f32 v112, v112
    v_exp_f32 v113, v113
    v_exp_f32 v114, v114
    s_waitcnt lgkmcnt(0)
    v_mfma_f32_32x32x16_bf16 v[94:109], v[138:141], v[76:79], 0
    s_mov_b32 m0, s19
    s_add_u32 s19, s19, 1024
    buffer_load_dwordx4 v5, s[60:63], s20 offen lds
    s_add_u32 s20, s20, 8192
    v_exp_f32 v115, v115
    v_exp_f32 v116, v116
    v_exp_f32 v117, v117
    v_exp_f32 v118, v118
    v_exp_f32 v119, v119
    v_exp_f32 v120, v120
    v_smfmac_f32_32x32x32_bf16 v[60:75], v[130:133], v[110:117], v22
    v_exp_f32 v121, v121
    v_exp_f32 v122, v122
    v_exp_f32 v123, v123
    v_exp_f32 v124, v124
    v_exp_f32 v125, v125
    v_exp_f32 v94, v94
    v_exp_f32 v95, v95
    v_smfmac_f32_32x32x32_bf16 v[60:75], v[134:137], v[118:125], v22
    ds_read_b128 v[126:129], v23 offset:20800
    v_exp_f32 v96, v96
    v_exp_f32 v97, v97
    v_exp_f32 v98, v98
    v_mfma_f32_32x32x16_bf16 v[110:125], v[138:141], v[80:83], 0
    ds_read_b128 v[134:137], v25 offset:20800
    v_exp_f32 v99, v99
    v_exp_f32 v100, v100
    v_exp_f32 v101, v101
    v_exp_f32 v102, v102
    v_exp_f32 v103, v103
    v_exp_f32 v104, v104
    v_smfmac_f32_32x32x32_bf16 v[44:59], v[142:145], v[94:101], v22
    ds_read_b128 v[130:133], v24 offset:20800
    v_exp_f32 v105, v105
    v_exp_f32 v106, v106
    v_exp_f32 v107, v107
    v_exp_f32 v108, v108
    v_exp_f32 v109, v109
    s_setprio 2
    v_exp_f32 v110, v110
    v_exp_f32 v111, v111
    v_smfmac_f32_32x32x32_bf16 v[44:59], v[146:149], v[102:109], v22
    v_exp_f32 v112, v112
    v_exp_f32 v113, v113
    v_exp_f32 v114, v114
    s_waitcnt lgkmcnt(0)
    v_mfma_f32_32x32x16_bf16 v[94:109], v[126:129], v[76:79], 0
    v_exp_f32 v115, v115
    v_exp_f32 v116, v116
    v_exp_f32 v117, v117
    v_exp_f32 v118, v118
    v_exp_f32 v119, v119
    v_exp_f32 v120, v120
    v_smfmac_f32_32x32x32_bf16 v[60:75], v[142:145], v[110:117], v22
    v_exp_f32 v121, v121
    v_exp_f32 v122, v122
    v_exp_f32 v123, v123
    v_exp_f32 v124, v124
    v_exp_f32 v125, v125
    v_exp_f32 v94, v94
    v_exp_f32 v95, v95
    v_smfmac_f32_32x32x32_bf16 v[60:75], v[146:149], v[118:125], v22
    ds_read_b128 v[138:141], v23 offset:22880
    v_exp_f32 v96, v96
    v_exp_f32 v97, v97
    v_exp_f32 v98, v98
    v_mfma_f32_32x32x16_bf16 v[110:125], v[126:129], v[80:83], 0
    ds_read_b128 v[146:149], v25 offset:22880
    v_exp_f32 v99, v99
    v_exp_f32 v100, v100
    v_exp_f32 v101, v101
    v_exp_f32 v102, v102
    v_exp_f32 v103, v103
    v_exp_f32 v104, v104
    v_smfmac_f32_32x32x32_bf16 v[44:59], v[130:133], v[94:101], v22
    ds_read_b128 v[142:145], v24 offset:22880
    v_exp_f32 v105, v105
    v_exp_f32 v106, v106
    v_exp_f32 v107, v107
    v_exp_f32 v108, v108
    v_exp_f32 v109, v109
    s_setprio 1
    v_exp_f32 v110, v110
    v_exp_f32 v111, v111
    v_smfmac_f32_32x32x32_bf16 v[44:59], v[134:137], v[102:109], v22
    v_exp_f32 v112, v112
    v_exp_f32 v113, v113
    v_exp_f32 v114, v114
    s_waitcnt lgkmcnt(0)
    v_mfma_f32_32x32x16_bf16 v[94:109], v[138:141], v[76:79], 0
    v_exp_f32 v115, v115
    v_exp_f32 v116, v116
    v_exp_f32 v117, v117
    v_exp_f32 v118, v118
    v_exp_f32 v119, v119
    v_exp_f32 v120, v120
    v_smfmac_f32_32x32x32_bf16 v[60:75], v[130:133], v[110:117], v22
    v_exp_f32 v121, v121
    v_exp_f32 v122, v122
    v_exp_f32 v123, v123
    v_exp_f32 v124, v124
    v_exp_f32 v125, v125
    v_exp_f32 v94, v94
    v_exp_f32 v95, v95
    v_smfmac_f32_32x32x32_bf16 v[60:75], v[134:137], v[118:125], v22
    v_exp_f32 v96, v96
    v_exp_f32 v97, v97
    v_exp_f32 v98, v98
    v_mfma_f32_32x32x16_bf16 v[110:125], v[138:141], v[80:83], 0
    v_exp_f32 v99, v99
    v_exp_f32 v100, v100
    v_exp_f32 v101, v101
    v_exp_f32 v102, v102
    v_exp_f32 v103, v103
    v_exp_f32 v104, v104
    v_smfmac_f32_32x32x32_bf16 v[44:59], v[142:145], v[94:101], v22
    v_exp_f32 v105, v105
    v_exp_f32 v106, v106
    v_exp_f32 v107, v107
    v_exp_f32 v108, v108
    v_exp_f32 v109, v109
    s_setprio 0
    v_exp_f32 v110, v110
    v_exp_f32 v111, v111
    v_smfmac_f32_32x32x32_bf16 v[44:59], v[146:149], v[102:109], v22
    v_lshrrev_b32 v9, 3, v28
    buffer_load_dword v84, v9, s[8:11], s31 offen sc1
    v_exp_f32 v112, v112
    v_exp_f32 v113, v113
    v_exp_f32 v114, v114
    v_exp_f32 v115, v115
    v_exp_f32 v116, v116
    v_exp_f32 v117, v117
    v_exp_f32 v118, v118
    v_exp_f32 v119, v119
    v_exp_f32 v120, v120
    v_smfmac_f32_32x32x32_bf16 v[60:75], v[142:145], v[110:117], v22
    v_exp_f32 v121, v121
    v_exp_f32 v122, v122
    v_exp_f32 v123, v123
    v_exp_f32 v124, v124
    v_exp_f32 v125, v125
    s_nop 1
    v_smfmac_f32_32x32x32_bf16 v[60:75], v[146:149], v[118:125], v22
    s_setprio 0
    v_add_u32 v10, 163584, v43
    ds_read_b32 v10, v10
    s_mov_b32 s72, 0x2f800000
    s_mov_b32 s73, 0x53800000
    v_cmp_nge_f32 vcc, v52, s72
    v_cmp_nle_f32 s[74:75], v52, s73
    v_mov_b32 v53, 0
    s_or_b64 vcc, vcc, s[74:75]
    s_nop 2
    v_cmp_nge_f32 s[74:75], v68, s72
    v_cmp_nle_f32 s[78:79], v68, s73
    v_mov_b32 v69, 0
    s_or_b64 vcc, vcc, s[74:75]
    s_or_b64 vcc, vcc, s[78:79]
    s_cbranch_vccnz L_slow
L_back:
    s_cmp_eq_u32 s83, 0
    s_cbranch_scc1 L_keep0
    ds_write_b128 v41, v[44:47] offset:0
    ds_write_b128 v41, v[48:51] offset:1024
    ds_write_b128 v41, v[52:55] offset:2048
    s_waitcnt vmcnt(1)
    s_waitcnt lgkmcnt(0)
    s_barrier
    ds_read_b64 v[102:103], v42 offset:2048
    ds_read_b128 v[94:97], v42
    ds_read_b128 v[98:101], v42 offset:1024
    v_cmp_ne_u32 vcc, s36, v10
    s_waitcnt lgkmcnt(2)
    v_max_f32 v6, v69, v103
    v_sub_f32 v7, v69, v6
    v_sub_f32 v8, v103, v6
    v_exp_f32 v7, v7
    v_exp_f32 v8, v8
    v_mul_f32 v6, v68, v7
    v_fmac_f32 v6, v102, v8
    v_rcp_f32 v6, v6
    s_nop 0
    v_mul_f32 v68, v7, v6
    v_mul_f32 v102, v8, v6
    v_pk_mul_f32 v[60:61], v[60:61], v[68:69] op_sel:[0,0] op_sel_hi:[1,0]
    v_pk_mul_f32 v[62:63], v[62:63], v[68:69] op_sel:[0,0] op_sel_hi:[1,0]
    v_pk_mul_f32 v[64:65], v[64:65], v[68:69] op_sel:[0,0] op_sel_hi:[1,0]
    v_pk_mul_f32 v[66:67], v[66:67], v[68:69] op_sel:[0,0] op_sel_hi:[1,0]
    s_waitcnt lgkmcnt(0)
    v_pk_fma_f32 v[60:61], v[94:95], v[102:103], v[60:61] op_sel:[0,0,0] op_sel_hi:[1,0,1]
    v_pk_fma_f32 v[62:63], v[96:97], v[102:103], v[62:63] op_sel:[0,0,0] op_sel_hi:[1,0,1]
    v_pk_fma_f32 v[64:65], v[98:99], v[102:103], v[64:65] op_sel:[0,0,0] op_sel_hi:[1,0,1]
    v_pk_fma_f32 v[66:67], v[100:101], v[102:103], v[66:67] op_sel:[0,0,0] op_sel_hi:[1,0,1]
    v_cvt_pk_bf16_f32 v90, v60, v61
    v_cvt_pk_bf16_f32 v91, v62, v63
    v_cvt_pk_bf16_f32 v92, v64, v65
    v_cvt_pk_bf16_f32 v93, v66, v67
    s_branch L_norm
L_keep0:
    ds_write_b128 v41, v[60:63] offset:0
    ds_write_b128 v41, v[64:67] offset:1024
    ds_write_b128 v41, v[68:71] offset:2048
    s_waitcnt vmcnt(1)
    s_waitcnt lgkmcnt(0)
    s_barrier
    ds_read_b64 v[102:103], v42 offset:2048
    ds_read_b128 v[94:97], v42
    ds_read_b128 v[98:101], v42 offset:1024
    v_cmp_ne_u32 vcc, s36, v10
    s_waitcnt lgkmcnt(2)
    v_max_f32 v6, v53, v103
    v_sub_f32 v7, v53, v6
    v_sub_f32 v8, v103, v6
    v_exp_f32 v7, v7
    v_exp_f32 v8, v8
    v_mul_f32 v6, v52, v7
    v_fmac_f32 v6, v102, v8
    v_rcp_f32 v6, v6
    s_nop 0
    v_mul_f32 v52, v7, v6
    v_mul_f32 v102, v8, v6
    v_pk_mul_f32 v[44:45], v[44:45], v[52:53] op_sel:[0,0] op_sel_hi:[1,0]
    v_pk_mul_f32 v[46:47], v[46:47], v[52:53] op_sel:[0,0] op_sel_hi:[1,0]
    v_pk_mul_f32 v[48:49], v[48:49], v[52:53] op_sel:[0,0] op_sel_hi:[1,0]
    v_pk_mul_f32 v[50:51], v[50:51], v[52:53] op_sel:[0,0] op_sel_hi:[1,0]
    s_waitcnt lgkmcnt(0)
    v_pk_fma_f32 v[44:45], v[94:95], v[102:103], v[44:45] op_sel:[0,0,0] op_sel_hi:[1,0,1]
    v_pk_fma_f32 v[46:47], v[96:97], v[102:103], v[46:47] op_sel:[0,0,0] op_sel_hi:[1,0,1]
    v_pk_fma_f32 v[48:49], v[98:99], v[102:103], v[48:49] op_sel:[0,0,0] op_sel_hi:[1,0,1]
    v_pk_fma_f32 v[50:51], v[100:101], v[102:103], v[50:51] op_sel:[0,0,0] op_sel_hi:[1,0,1]
    v_cvt_pk_bf16_f32 v90, v44, v45
    v_cvt_pk_bf16_f32 v91, v46, v47
    v_cvt_pk_bf16_f32 v92, v48, v49
    v_cvt_pk_bf16_f32 v93, v50, v51
L_norm:
    s_cbranch_vccz L_o_l2
    buffer_store_dwordx4 v[90:93], v4, s[8:11], s28 offen sc1
    s_add_u32 s72, s26, 64
    s_waitcnt vmcnt(0)
    s_mov_b64 exec, 1
    buffer_store_dword v11, v19, s[8:11], s72 offen sc1
    s_mov_b64 exec, -1
    s_branch L_o_st
L_o_l2:
    buffer_store_dwordx4 v[90:93], v4, s[8:11], s28 offen
    s_add_u32 s72, s26, 64
    s_waitcnt vmcnt(0)
    s_mov_b64 exec, 1
    buffer_store_dword v11, v19, s[8:11], s72 offen
    s_mov_b64 exec, -1
L_o_st:
    buffer_load_dword v60, v43, s[8:11], s27 offen offset:64 sc1
    v_bfe_u32 v6, v1, 2, 2
    v_lshl_add_u32 v7, v3, 2, v6
    v_lshlrev_b32 v26, 7, v7
    v_bfe_u32 v7, v1, 4, 1
    v_lshlrev_b32 v7, 1, v7
    v_bfe_u32 v8, v1, 1, 1
    v_add_u32 v7, v7, v8
    v_lshrrev_b32 v6, 1, v6
    v_xor_b32 v6, s34, v6
    v_lshl_add_u32 v7, v6, 2, v7
    v_lshl_add_u32 v26, v7, 4, v26
    v_and_b32 v8, 1, v1
    v_lshl_add_u32 v26, v8, 3, v26
    v_add_u32 v26, 98048, v26
    s_lshl_b32 s74, s35, 15
    v_add_u32 v27, s74, v4
    s_lshl_b32 s73, s35, 5
    v_add_u32 v6, s73, v2
    v_mul_u32_u24 v6, 144, v6
    v_lshl_add_u32 v6, v3, 3, v6
    s_lshl_b32 s72, s34, 6
    s_add_u32 s72, s72, 65536
    v_add_u32 v29, s72, v6
    v_mov_b32 v23, v9
    s_waitcnt vmcnt(0)
    s_mov_b32 s82, 400000
L_poll5:
    v_cmp_ne_u32 vcc, s7, v60
    s_nop 4
    s_cbranch_vccz L_poll5_ok
    buffer_load_dword v60, v43, s[8:11], s27 offen offset:64 sc1
    s_waitcnt vmcnt(0)
    s_sub_u32 s82, s82, 1
    s_cmp_lg_u32 s82, 0
    s_cbranch_scc1 L_poll5
L_poll5_ok:
    s_lshl_b32 s73, s3, 12
    s_add_u32 m0, s73, 0
    s_nop 0
    buffer_load_dwordx4 v4, s[8:11], s29 offen sc1 lds
    s_add_u32 s29, s29, 1024
    s_add_u32 m0, s73, 2048
    s_nop 0
    buffer_load_dwordx4 v4, s[8:11], s29 offen sc1 lds
    s_add_u32 s29, s29, 1024
    s_add_u32 m0, s73, 32768
    s_nop 0
    buffer_load_dwordx4 v4, s[8:11], s29 offen sc1 lds
    s_add_u32 s29, s29, 1024
    s_add_u32 m0, s73, 34816
    s_nop 0
    buffer_load_dwordx4 v4, s[8:11], s29 offen sc1 lds
    s_add_u32 s29, s29, 1024
    s_add_u32 m0, s73, 1024
    s_nop 0
    buffer_load_dwordx4 v4, s[8:11], s29 offen sc1 lds
    s_add_u32 s29, s29, 1024
    s_add_u32 m0, s73, 3072
    s_nop 0
    buffer_load_dwordx4 v4, s[8:11], s29 offen sc1 lds
    s_add_u32 s29, s29, 1024
    s_add_u32 m0, s73, 33792
    s_nop 0
    buffer_load_dwordx4 v4, s[8:11], s29 offen sc1 lds
    s_add_u32 s29, s29, 1024
    s_add_u32 m0, s73, 35840
    s_nop 0
    buffer_load_dwordx4 v4, s[8:11], s29 offen sc1 lds
    s_add_u32 s29, s29, 1024
    s_cmp_ge_u32 s3, 4
    s_cbranch_scc1 L_nopre
    ds_read_b64_tr_b16 v[150:151], v26 offset:0
    ds_read_b64_tr_b16 v[152:153], v26 offset:1024
    ds_read_b64_tr_b16 v[154:155], v26 offset:2048
    ds_read_b64_tr_b16 v[156:157], v26 offset:3072
    ds_read_b64_tr_b16 v[158:159], v26 offset:4096
    ds_read_b64_tr_b16 v[160:161], v26 offset:5120
    ds_read_b64_tr_b16 v[162:163], v26 offset:6144
    ds_read_b64_tr_b16 v[164:165], v26 offset:7168
    ds_read_b64_tr_b16 v[166:167], v26 offset:8192
    ds_read_b64_tr_b16 v[168:169], v26 offset:9216
    ds_read_b64_tr_b16 v[170:171], v26 offset:10240
    ds_read_b64_tr_b16 v[172:173], v26 offset:11264
    ds_read_b64_tr_b16 v[174:175], v26 offset:12288
    ds_read_b64_tr_b16 v[176:177], v26 offset:13312
    ds_read_b64_tr_b16 v[178:179], v26 offset:14336
    ds_read_b64_tr_b16 v[180:181], v26 offset:15360
    ds_read_b64_tr_b16 v[182:183], v26 offset:16384
    ds_read_b64_tr_b16 v[184:185], v26 offset:17408
    ds_read_b64_tr_b16 v[186:187], v26 offset:18432
    ds_read_b64_tr_b16 v[188:189], v26 offset:19456
    ds_read_b64_tr_b16 v[190:191], v26 offset:20480
    ds_read_b64_tr_b16 v[192:193], v26 offset:21504
    ds_read_b64_tr_b16 v[194:195], v26 offset:22528
    ds_read_b64_tr_b16 v[196:197], v26 offset:23552
    ds_read_b64_tr_b16 v[198:199], v26 offset:24576
    ds_read_b64_tr_b16 v[200:201], v26 offset:25600
    ds_read_b64_tr_b16 v[202:203], v26 offset:26624
    ds_read_b64_tr_b16 v[204:205], v26 offset:27648
    ds_read_b64_tr_b16 v[206:207], v26 offset:28672
    ds_read_b64_tr_b16 v[208:209], v26 offset:29696
    ds_read_b64_tr_b16 v[210:211], v26 offset:30720
    ds_read_b64_tr_b16 v[212:213], v26 offset:31744
    ds_read_b64_tr_b16 v[214:215], v26 offset:32768
    ds_read_b64_tr_b16 v[216:217], v26 offset:33792
    ds_read_b64_tr_b16 v[218:219], v26 offset:34816
    ds_read_b64_tr_b16 v[220:221], v26 offset:35840
    ds_read_b64_tr_b16 v[222:223], v26 offset:36864
    ds_read_b64_tr_b16 v[224:225], v26 offset:37888
    ds_read_b64_tr_b16 v[226:227], v26 offset:38912
    ds_read_b64_tr_b16 v[228:229], v26 offset:39936
    ds_read_b64_tr_b16 v[230:231], v26 offset:40960
    ds_read_b64_tr_b16 v[232:233], v26 offset:41984
    ds_read_b64_tr_b16 v[234:235], v26 offset:43008
    ds_read_b64_tr_b16 v[236:237], v26 offset:44032
    ds_read_b64_tr_b16 v[238:239], v26 offset:45056
    ds_read_b64_tr_b16 v[240:241], v26 offset:46080
    ds_read_b64_tr_b16 v[242:243], v26 offset:47104
    ds_read_b64_tr_b16 v[244:245], v26 offset:48128
L_nopre:
    v_mul_u32_u24 v6, 144, v34
    s_lshl_b32 s72, s3, 4
    s_add_u32 s72, s72, 75776
    v_add_u32 v6, s72, v6
    v_lshrrev_b32 v7, 3, v0
    v_and_b32 v8, 7, v0
    v_subrev_u32 v9, 16256, v30
    v_lshlrev_b32 v7, 11, v7
    v_lshl_add_u32 v7, v8, 4, v7
    s_waitcnt vmcnt(4) lgkmcnt(0)
    s_barrier
    s_mov_b32 s82, 400000
L_poll4:
    v_cmp_ne_u32 vcc, s7, v84
    s_nop 4
    s_cbranch_vccz L_poll4_ok
    buffer_load_dword v84, v23, s[8:11], s31 offen sc1
    s_waitcnt vmcnt(0)
    s_sub_u32 s82, s82, 1
    s_cmp_lg_u32 s82, 0
    s_cbranch_scc1 L_poll4
L_poll4_ok:
    buffer_load_dwordx4 v[86:89], v33, s[8:11], s32 offen sc1
    s_cmp_lt_u32 s3, 4
    s_cbranch_scc1 L_proj
    s_waitcnt vmcnt(1)
    s_barrier
    s_waitcnt vmcnt(0)
    v_permlane32_swap_b32 v86, v88
    v_permlane32_swap_b32 v87, v89
    s_nop 1
    v_permlane16_swap_b32 v86, v87
    v_permlane16_swap_b32 v88, v89
    ds_write_b128 v6, v[86:89]
    s_branch L_noproj
L_proj:
    ds_read_b128 v[94:97], v27 offset:0
    ds_read_b128 v[98:101], v27 offset:2048
    ds_read_b128 v[102:105], v27 offset:4096
    ds_read_b128 v[106:109], v27 offset:6144
    s_waitcnt lgkmcnt(3)
    v_mfma_f32_32x32x16_bf16 v[44:59], v[150:153], v[94:97], 0
    ds_read_b128 v[110:113], v27 offset:8192
    s_waitcnt lgkmcnt(3)
    v_mfma_f32_32x32x16_bf16 v[44:59], v[158:161], v[98:101], v[44:59]
    ds_read_b128 v[114:117], v27 offset:10240
    s_waitcnt lgkmcnt(3)
    v_mfma_f32_32x32x16_bf16 v[44:59], v[166:169], v[102:105], v[44:59]
    ds_read_b128 v[94:97], v27 offset:12288
    s_waitcnt lgkmcnt(3)
    v_mfma_f32_32x32x16_bf16 v[44:59], v[174:177], v[106:109], v[44:59]
    ds_read_b128 v[98:101], v27 offset:14336
    s_waitcnt lgkmcnt(3)
    v_mfma_f32_32x32x16_bf16 v[44:59], v[182:185], v[110:113], v[44:59]
    ds_read_b128 v[102:105], v27 offset:16384
    s_waitcnt lgkmcnt(3)
    v_mfma_f32_32x32x16_bf16 v[44:59], v[190:193], v[114:117], v[44:59]
    ds_read_b128 v[106:109], v27 offset:18432
    s_waitcnt lgkmcnt(3)
    v_mfma_f32_32x32x16_bf16 v[44:59], v[198:201], v[94:97], v[44:59]
    ds_read_b128 v[110:113], v27 offset:20480
    s_waitcnt lgkmcnt(3)
    v_mfma_f32_32x32x16_bf16 v[44:59], v[206:209], v[98:101], v[44:59]
    ds_read_b128 v[114:117], v27 offset:22528
    s_waitcnt lgkmcnt(3)
    v_mfma_f32_32x32x16_bf16 v[44:59], v[214:217], v[102:105], v[44:59]
    ds_read_b128 v[94:97], v27 offset:24576
    ds_read_b64_tr_b16 v[126:127], v26 offset:49152
    ds_read_b64_tr_b16 v[128:129], v26 offset:50176
    s_waitcnt lgkmcnt(5)
    v_mfma_f32_32x32x16_bf16 v[44:59], v[222:225], v[106:109], v[44:59]
    ds_read_b128 v[98:101], v27 offset:26624
    ds_read_b64_tr_b16 v[130:131], v26 offset:53248
    ds_read_b64_tr_b16 v[132:133], v26 offset:54272
    s_waitcnt lgkmcnt(7)
    v_mfma_f32_32x32x16_bf16 v[44:59], v[230:233], v[110:113], v[44:59]
    ds_read_b128 v[102:105], v27 offset:28672
    ds_read_b64_tr_b16 v[134:135], v26 offset:57344
    ds_read_b64_tr_b16 v[136:137], v26 offset:58368
    s_waitcnt lgkmcnt(9)
    v_mfma_f32_32x32x16_bf16 v[44:59], v[238:241], v[114:117], v[44:59]
    ds_read_b128 v[106:109], v27 offset:30720
    ds_read_b64_tr_b16 v[138:139], v26 offset:61440
    ds_read_b64_tr_b16 v[140:141], v26 offset:62464
    s_waitcnt lgkmcnt(9)
    v_mfma_f32_32x32x16_bf16 v[44:59], v[126:129], v[94:97], v[44:59]
    s_waitcnt vmcnt(1)
    s_barrier
    ds_read_b128 v[110:113], v27 offset:1024
    s_waitcnt lgkmcnt(7)
    v_mfma_f32_32x32x16_bf16 v[44:59], v[130:133], v[98:101], v[44:59]
    ds_read_b128 v[114:117], v27 offset:3072
    s_waitcnt lgkmcnt(5)
    v_mfma_f32_32x32x16_bf16 v[44:59], v[134:137], v[102:105], v[44:59]
    ds_read_b128 v[94:97], v27 offset:5120
    s_waitcnt lgkmcnt(3)
    v_mfma_f32_32x32x16_bf16 v[44:59], v[138:141], v[106:109], v[44:59]
    ds_read_b128 v[98:101], v27 offset:7168
    s_waitcnt lgkmcnt(3)
    v_mfma_f32_32x32x16_bf16 v[44:59], v[154:157], v[110:113], v[44:59]
    ds_read_b128 v[102:105], v27 offset:9216
    s_waitcnt lgkmcnt(3)
    v_mfma_f32_32x32x16_bf16 v[44:59], v[162:165], v[114:117], v[44:59]
    ds_read_b128 v[106:109], v27 offset:11264
    s_waitcnt lgkmcnt(3)
    v_mfma_f32_32x32x16_bf16 v[44:59], v[170:173], v[94:97], v[44:59]
    ds_read_b128 v[110:113], v27 offset:13312
    s_waitcnt lgkmcnt(3)
    v_mfma_f32_32x32x16_bf16 v[44:59], v[178:181], v[98:101], v[44:59]
    ds_read_b128 v[114:117], v27 offset:15360
    s_waitcnt lgkmcnt(3)
    v_mfma_f32_32x32x16_bf16 v[44:59], v[186:189], v[102:105], v[44:59]
    ds_read_b128 v[94:97], v27 offset:17408
    s_waitcnt lgkmcnt(3)
    v_mfma_f32_32x32x16_bf16 v[44:59], v[194:197], v[106:109], v[44:59]
    ds_read_b128 v[98:101], v27 offset:19456
    s_waitcnt lgkmcnt(3)
    v_mfma_f32_32x32x16_bf16 v[44:59], v[202:205], v[110:113], v[44:59]
    ds_read_b128 v[102:105], v27 offset:21504
    s_waitcnt lgkmcnt(3)
    v_mfma_f32_32x32x16_bf16 v[44:59], v[210:213], v[114:117], v[44:59]
    ds_read_b128 v[106:109], v27 offset:23552
    s_waitcnt lgkmcnt(3)
    v_mfma_f32_32x32x16_bf16 v[44:59], v[218:221], v[94:97], v[44:59]
    ds_read_b128 v[110:113], v27 offset:25600
    ds_read_b64_tr_b16 v[142:143], v26 offset:51200
    ds_read_b64_tr_b16 v[144:145], v26 offset:52224
    s_waitcnt lgkmcnt(5)
    v_mfma_f32_32x32x16_bf16 v[44:59], v[226:229], v[98:101], v[44:59]
    ds_read_b128 v[114:117], v27 offset:27648
    ds_read_b64_tr_b16 v[146:147], v26 offset:55296
    ds_read_b64_tr_b16 v[148:149], v26 offset:56320
    s_waitcnt lgkmcnt(7)
    v_mfma_f32_32x32x16_bf16 v[44:59], v[234:237], v[102:105], v[44:59]
    ds_read_b128 v[94:97], v27 offset:29696
    ds_read_b64_tr_b16 v[126:127], v26 offset:59392
    ds_read_b64_tr_b16 v[128:129], v26 offset:60416
    s_waitcnt lgkmcnt(9)
    v_mfma_f32_32x32x16_bf16 v[44:59], v[242:245], v[106:109], v[44:59]
    ds_read_b128 v[98:101], v27 offset:31744
    ds_read_b64_tr_b16 v[130:131], v26 offset:63488
    ds_read_b64_tr_b16 v[132:133], v26 offset:64512
    s_waitcnt vmcnt(0)
    v_permlane32_swap_b32 v86, v88
    v_permlane32_swap_b32 v87, v89
    s_nop 1
    v_permlane16_swap_b32 v86, v87
    v_permlane16_swap_b32 v88, v89
    ds_write_b128 v6, v[86:89]
    s_waitcnt lgkmcnt(10)
    v_mfma_f32_32x32x16_bf16 v[44:59], v[142:145], v[110:113], v[44:59]
    s_waitcnt lgkmcnt(7)
    v_mfma_f32_32x32x16_bf16 v[44:59], v[146:149], v[114:117], v[44:59]
    s_waitcnt lgkmcnt(4)
    v_mfma_f32_32x32x16_bf16 v[44:59], v[126:129], v[94:97], v[44:59]
    s_waitcnt lgkmcnt(0)
    v_mfma_f32_32x32x16_bf16 v[44:59], v[130:133], v[98:101], v[44:59]
    s_nop 11
    v_cvt_pk_bf16_f32 v150, v44, v45
    v_cvt_pk_bf16_f32 v151, v46, v47
    ds_write_b64 v29, v[150:151] offset:0
    v_cvt_pk_bf16_f32 v152, v48, v49
    v_cvt_pk_bf16_f32 v153, v50, v51
    ds_write_b64 v29, v[152:153] offset:16
    v_cvt_pk_bf16_f32 v154, v52, v53
    v_cvt_pk_bf16_f32 v155, v54, v55
    ds_write_b64 v29, v[154:155] offset:32
    v_cvt_pk_bf16_f32 v156, v56, v57
    v_cvt_pk_bf16_f32 v157, v58, v59
    ds_write_b64 v29, v[156:157] offset:48
L_noproj:
    s_waitcnt lgkmcnt(0)
    s_barrier
    ds_read_b128 v[94:97], v9
    ds_read_b128 v[98:101], v9 offset:10240
    s_waitcnt lgkmcnt(1)
    buffer_store_dwordx4 v[94:97], v7, s[68:71], s33 offen nt
    s_waitcnt lgkmcnt(0)
    buffer_store_dwordx4 v[98:101], v7, s[68:71], s33 offen offset:1024 nt
    s_or_b32 s72, s2, s3
    s_cmp_eq_u32 s72, 0
    s_cbranch_scc0 L_noep
    s_mov_b64 exec, 1
    buffer_store_dword v11, v19, s[8:11], 0 offen
L_noep:
L_end:
    s_endpgm
L_slow:
    s_nop 7
    s_nop 7
    v_lshlrev_b32 v8, 4, v2
    v_lshl_add_u32 v8, v3, 8, v8
    v_add_u32 v8, 131072, v8
    v_mov_b32 v6, 0xff800000
    v_mov_b32 v7, 0xff800000
    s_mov_b32 s82, 0
L_slow1:
    s_lshr_b32 s72, s82, 2
    s_lshl_b32 s72, s72, 1
    s_add_u32 s72, s72, s83
    s_lshl_b32 s72, s72, 2
    s_and_b32 s73, s82, 3
    s_add_u32 s72, s72, s73
    s_lshl_b32 s72, s72, 11
    buffer_load_dwordx4 v[126:129], v20, s[8:11], s72 offen sc1
    s_waitcnt vmcnt(0)
    v_mfma_f32_32x32x16_bf16 v[94:109], v[126:129], v[76:79], 0
    v_mfma_f32_32x32x16_bf16 v[110:125], v[126:129], v[80:83], 0
    s_nop 10
    v_max3_f32 v6, v94, v95, v6
    v_max3_f32 v6, v96, v97, v6
    v_max3_f32 v6, v98, v99, v6
    v_max3_f32 v6, v100, v101, v6
    v_max3_f32 v6, v102, v103, v6
    v_max3_f32 v6, v104, v105, v6
    v_max3_f32 v6, v106, v107, v6
    v_max3_f32 v6, v108, v109, v6
    v_max3_f32 v7, v110, v111, v7
    v_max3_f32 v7, v112, v113, v7
    v_max3_f32 v7, v114, v115, v7
    v_max3_f32 v7, v116, v117, v7
    v_max3_f32 v7, v118, v119, v7
    v_max3_f32 v7, v120, v121, v7
    v_max3_f32 v7, v122, v123, v7
    v_max3_f32 v7, v124, v125, v7
    s_add_u32 s82, s82, 1
    s_cmp_lg_u32 s82, 32
    s_cbranch_scc1 L_slow1
    v_mov_b32 v94, v6
    s_nop 1
    v_permlane32_swap_b32 v94, v6
    v_max_f32 v6, v6, v94
    v_mov_b32 v94, v7
    s_nop 1
    v_permlane32_swap_b32 v94, v7
    v_max_f32 v7, v7, v94
    v_mov_b32 v44, 0
    v_mov_b32 v60, 0
    v_mov_b32 v45, 0
    v_mov_b32 v61, 0
    v_mov_b32 v46, 0
    v_mov_b32 v62, 0
    v_mov_b32 v47, 0
    v_mov_b32 v63, 0
    v_mov_b32 v48, 0
    v_mov_b32 v64, 0
    v_mov_b32 v49, 0
    v_mov_b32 v65, 0
    v_mov_b32 v50, 0
    v_mov_b32 v66, 0
    v_mov_b32 v51, 0
    v_mov_b32 v67, 0
    v_mov_b32 v52, 0
    v_mov_b32 v68, 0
    v_mov_b32 v53, 0
    v_mov_b32 v69, 0
    v_mov_b32 v54, 0
    v_mov_b32 v70, 0
    v_mov_b32 v55, 0
    v_mov_b32 v71, 0
    v_mov_b32 v56, 0
    v_mov_b32 v72, 0
    v_mov_b32 v57, 0
    v_mov_b32 v73, 0
    v_mov_b32 v58, 0
    v_mov_b32 v74, 0
    v_mov_b32 v59, 0
    v_mov_b32 v75, 0
    v_mov_b32 v130, 0x3f803f80
    v_mov_b32 v131, 0x3f803f80
    v_mov_b32 v132, 0x3f803f80
    v_mov_b32 v133, 0x3f803f80
    v_mov_b32 v134, 0x3f803f80
    v_mov_b32 v135, 0x3f803f80
    v_mov_b32 v136, 0x3f803f80
    v_mov_b32 v137, 0x3f803f80
    s_mov_b32 s82, 0
    s_mov_b32 s74, 0xffff
    s_mov_b32 s75, 0xffff
L_slow2:
    s_lshr_b32 s72, s82, 2
    s_lshl_b32 s72, s72, 1
    s_add_u32 s72, s72, s83
    s_lshl_b32 s72, s72, 2
    s_and_b32 s73, s82, 3
    s_add_u32 s72, s72, s73
    s_lshl_b32 s72, s72, 11
    buffer_load_dwordx4 v[126:129], v20, s[8:11], s72 offen sc1
    s_mov_b64 exec, s[74:75]
    buffer_load_dwordx4 v[130:133], v8, s[8:11], s72 offen offset:1024 sc1
    buffer_load_dwordx4 v[134:137], v8, s[8:11], s72 offen offset:1536 sc1
    s_mov_b64 exec, -1
    s_waitcnt vmcnt(0)
    v_mfma_f32_32x32x16_bf16 v[94:109], v[126:129], v[76:79], 0
    v_mfma_f32_32x32x16_bf16 v[110:125], v[126:129], v[80:83], 0
    s_nop 10
    v_sub_f32 v94, v94, v6
    v_sub_f32 v95, v95, v6
    v_sub_f32 v96, v96, v6
    v_sub_f32 v97, v97, v6
    v_sub_f32 v98, v98, v6
    v_sub_f32 v99, v99, v6
    v_sub_f32 v100, v100, v6
    v_sub_f32 v101, v101, v6
    v_sub_f32 v102, v102, v6
    v_sub_f32 v103, v103, v6
    v_sub_f32 v104, v104, v6
    v_sub_f32 v105, v105, v6
    v_sub_f32 v106, v106, v6
    v_sub_f32 v107, v107, v6
    v_sub_f32 v108, v108, v6
    v_sub_f32 v109, v109, v6
    v_exp_f32 v94, v94
    v_exp_f32 v95, v95
    v_exp_f32 v96, v96
    v_exp_f32 v97, v97
    v_exp_f32 v98, v98
    v_exp_f32 v99, v99
    v_exp_f32 v100, v100
    v_exp_f32 v101, v101
    v_exp_f32 v102, v102
    v_exp_f32 v103, v103
    v_exp_f32 v104, v104
    v_exp_f32 v105, v105
    v_exp_f32 v106, v106
    v_exp_f32 v107, v107
    v_exp_f32 v108, v108
    v_exp_f32 v109, v109
    v_smfmac_f32_32x32x32_bf16 v[44:59], v[130:133], v[94:101], v22
    s_nop 0
    v_smfmac_f32_32x32x32_bf16 v[44:59], v[134:137], v[102:109], v22
    v_sub_f32 v110, v110, v7
    v_sub_f32 v111, v111, v7
    v_sub_f32 v112, v112, v7
    v_sub_f32 v113, v113, v7
    v_sub_f32 v114, v114, v7
    v_sub_f32 v115, v115, v7
    v_sub_f32 v116, v116, v7
    v_sub_f32 v117, v117, v7
    v_sub_f32 v118, v118, v7
    v_sub_f32 v119, v119, v7
    v_sub_f32 v120, v120, v7
    v_sub_f32 v121, v121, v7
    v_sub_f32 v122, v122, v7
    v_sub_f32 v123, v123, v7
    v_sub_f32 v124, v124, v7
    v_sub_f32 v125, v125, v7
    v_exp_f32 v110, v110
    v_exp_f32 v111, v111
    v_exp_f32 v112, v112
    v_exp_f32 v113, v113
    v_exp_f32 v114, v114
    v_exp_f32 v115, v115
    v_exp_f32 v116, v116
    v_exp_f32 v117, v117
    v_exp_f32 v118, v118
    v_exp_f32 v119, v119
    v_exp_f32 v120, v120
    v_exp_f32 v121, v121
    v_exp_f32 v122, v122
    v_exp_f32 v123, v123
    v_exp_f32 v124, v124
    v_exp_f32 v125, v125
    v_smfmac_f32_32x32x32_bf16 v[60:75], v[130:133], v[110:117], v22
    s_nop 0
    v_smfmac_f32_32x32x32_bf16 v[60:75], v[134:137], v[118:125], v22
    s_nop 7
    s_nop 7
    s_add_u32 s82, s82, 1
    s_cmp_lg_u32 s82, 32
    s_cbranch_scc1 L_slow2
    v_mov_b32 v53, v6
    v_mov_b32 v69, v7
    s_branch L_back
L_codeend:
.section .rodata,"a"
.p2align 6
.amdhsa_kernel concat_heads__grouped_kv_mqa__ssm_conv_s4__prompt_kernel
  .amdhsa_next_free_vgpr 256
  .amdhsa_next_free_sgpr 102
  .amdhsa_accum_offset 256
  .amdhsa_group_segment_fixed_size 0
  .amdhsa_kernarg_size 136
  .amdhsa_user_sgpr_count 2
  .amdhsa_user_sgpr_kernarg_segment_ptr 1
  .amdhsa_system_sgpr_workgroup_id_x 1
  .amdhsa_float_denorm_mode_32 3
.end_amdhsa_kernel
```
